```python
import torch

def _softmax(x, axis=-1):
    return torch.softmax(x, dim=axis)
def _gelu(x):
    return torch.nn.functional.gelu(x, approximate="tanh")
def _silu(x):
    return torch.nn.functional.silu(x)
def _sigmoid(x):
    return torch.sigmoid(x)
def _layernorm(x, axis=-1, eps=1e-5):
    m = x.mean(dim=axis, keepdim=True)
    v = x.var(dim=axis, keepdim=True, unbiased=False)
    return (x - m) / torch.sqrt(v + eps)
def _scatter_add(tgt, idx, src, axis=0):
    return tgt.clone().index_add_(axis, idx, src)
def _segment_sum(src, seg, n):
    out = torch.zeros((n,) + src.shape[1:], dtype=src.dtype)
    return out.index_add_(0, seg, src)
def _pad(x, pw):
    flat = tuple(v for pair in reversed(pw) for v in pair)
    return torch.nn.functional.pad(x, flat)

kernel_name = 'standalone__mixer_channel_mlp__prompt'

def setup_inputs():

    _w = (lambda a: (lambda t: t.to(torch.bfloat16) if t.is_floating_point() else t)(torch.as_tensor(a)))
    B, S, D, F = 1, 2048, 512, 1792
    return {
        "x": _w((lambda *s: torch.randn(*s, dtype=torch.bfloat16) * 0.05)(B, S, D)),
        "w1": _w((lambda *s: torch.randn(*s, dtype=torch.bfloat16) * 0.8)(D, F) * (D ** -0.5)),
        "b1": _w((lambda *s: torch.randn(*s, dtype=torch.bfloat16) * 0.4)(F)),
        "w2": _w((lambda *s: torch.randn(*s, dtype=torch.bfloat16) * 0.05)(F, D) * (F ** -0.5)),
        "b2": _w((lambda *s: torch.randn(*s, dtype=torch.bfloat16) * 0.05)(D)),
    }

def reference(x, w1, b1, w2, b2):
    y = _layernorm(x, axis=-1)
    h = _gelu(torch.einsum("bsd,df->bsf", y, w1) + b1)
    return torch.einsum("bsf,fd->bsd", h, w2) + b2
```

```asm
; @launch grid=(256,1,1) block=(512,1,1) lds=163840
.amdgcn_target "amdgcn-amd-amdhsa--gfx950"
.text
.globl standalone__mixer_channel_mlp__prompt_kernel
.p2align 8
.type standalone__mixer_channel_mlp__prompt_kernel,@function
standalone__mixer_channel_mlp__prompt_kernel:
    s_cmp_ge_u32 s2, 256
    s_cbranch_scc1 L_end
    s_load_dwordx16 s[64:79], s[0:1], 0
    s_memrealtime s[62:63]
    s_cmp_ge_u32 s2, 8
    s_cbranch_scc1 L_nocpe
    s_getpc_b64 s[14:15]
    v_lshlrev_b32 v2, 7, v0
    v_cmp_gt_u32 vcc, L_end-standalone__mixer_channel_mlp__prompt_kernel-64, v2
    s_and_saveexec_b64 s[16:17], vcc
    s_cbranch_execz L_cpe1
    global_load_dword v255, v2, s[14:15]
L_cpe1:
    s_mov_b64 exec, s[16:17]
L_nocpe:
    v_lshrrev_b32 v1, 6, v0
    v_and_b32 v0, 63, v0
    s_and_b32 s43, s2, 7
    v_readfirstlane_b32 s3, v1
    s_lshr_b32 s44, s2, 3
    s_lshr_b32 s45, s44, 4
    s_lshl_b32 s4, s43, 1
    s_add_u32 s4, s4, s45
    s_and_b32 s5, s44, 15
    s_mov_b32 s10, 2097152
    s_mov_b32 s11, 0x20000
    s_cmp_lt_u32 s3, 4
    s_cbranch_scc1 L_comp
    s_cmp_ge_u32 s3, 6
    s_cbranch_scc1 L_serv
    s_mov_b32 s54, s43
    s_sub_u32 s42, s3, 4
    v_lshrrev_b32 v49, 4, v0
    v_and_b32 v51, 15, v0
    v_mul_u32_u24 v53, 3584, v49
    v_lshlrev_b32 v52, 1, v49
    v_xor_b32 v52, v52, v51
    v_lshl_add_u32 v36, v52, 4, v53
    v_add_u32 v37, 13312, v36
    v_xor_b32 v52, 8, v52
    v_lshl_add_u32 v52, v52, 4, v53
    v_add_u32 v38, 26624, v52
    v_add_u32 v39, 39936, v52
    s_mul_i32 s48, s42, 114688
    s_lshl_b32 s43, s5, 8
    s_add_u32 s48, s48, s43
    s_lshl_b32 s53, s42, 13
    s_mov_b32 s14, 1835008
    s_mov_b32 s15, 0x20000
    v_lshrrev_b32 v48, 3, v0
    v_and_b32 v50, 7, v0
    s_cmp_ge_u32 s5, 14
    s_cbranch_scc1 L_lspare
    v_xor_b32 v52, v49, v50
    v_lshlrev_b32 v52, 4, v52
    v_lshl_add_u32 v32, v48, 10, v52
    v_xor_b32 v33, 64, v32
    v_add_u32 v33, 7168, v33
    v_add_u32 v34, 14336, v32
    v_add_u32 v35, 14336, v33
    s_lshl_b32 s47, s4, 17
    s_lshl_b32 s43, s42, 16
    s_add_u32 s47, s47, s43
    s_waitcnt lgkmcnt(0)
    s_mov_b64 s[12:13], s[66:67]
    s_mov_b64 s[8:9], s[64:65]
    s_mul_i32 s44, s54, 229376
    s_add_u32 m0, s53, 16384
    s_add_u32 s44, s44, s48
    buffer_load_dwordx4 v36, s[12:15], s44 offen offset:0  lds
    buffer_load_dwordx4 v37, s[12:15], s44 offen offset:1024  lds
    buffer_load_dwordx4 v38, s[12:15], s44 offen offset:2048  lds
    buffer_load_dwordx4 v39, s[12:15], s44 offen offset:3072  lds
    s_add_u32 m0, s53, 20480
    s_add_u32 s44, s44, 57344
    buffer_load_dwordx4 v36, s[12:15], s44 offen offset:0  lds
    buffer_load_dwordx4 v37, s[12:15], s44 offen offset:1024  lds
    buffer_load_dwordx4 v38, s[12:15], s44 offen offset:2048  lds
    buffer_load_dwordx4 v39, s[12:15], s44 offen offset:3072  lds
    s_lshl_b32 s43, s54, 7
    s_add_u32 m0, s53, 0
    s_add_u32 s43, s43, s47
    buffer_load_dwordx4 v32, s[8:11], s43 offen offset:0  lds
    buffer_load_dwordx4 v33, s[8:11], s43 offen offset:1024  lds
    buffer_load_dwordx4 v34, s[8:11], s43 offen offset:2048  lds
    buffer_load_dwordx4 v35, s[8:11], s43 offen offset:3072  lds
    s_add_u32 s54, s54, 1
    s_and_b32 s54, s54, 7
    s_add_u32 m0, s53, 4096
    s_add_u32 s43, s43, 32768
    buffer_load_dwordx4 v32, s[8:11], s43 offen offset:0  lds
    buffer_load_dwordx4 v33, s[8:11], s43 offen offset:1024  lds
    buffer_load_dwordx4 v34, s[8:11], s43 offen offset:2048  lds
    buffer_load_dwordx4 v35, s[8:11], s43 offen offset:3072  lds
    s_mul_i32 s44, s54, 229376
    s_add_u32 m0, s53, 49152
    s_add_u32 s44, s44, s48
    buffer_load_dwordx4 v36, s[12:15], s44 offen offset:0  lds
    buffer_load_dwordx4 v37, s[12:15], s44 offen offset:1024  lds
    buffer_load_dwordx4 v38, s[12:15], s44 offen offset:2048  lds
    buffer_load_dwordx4 v39, s[12:15], s44 offen offset:3072  lds
    s_mov_b32 s36, 0x7654f210
    s_mov_b32 s37, 0x3bdcea98
    s_lshl_b32 s7, s5, 2
    s_lshr_b64 s[36:37], s[36:37], s7
    s_bfe_u32 s6, s36, 0x10003
    s_and_b32 s7, s36, 7
    s_mov_b32 s55, 0xffff0000
    s_mov_b64 s[36:37], s[72:73]
    s_mov_b32 s38, 1024
    s_mov_b32 s39, 0x20000
    s_mov_b64 s[24:25], s[74:75]
    s_mov_b32 s26, 2097152
    s_mov_b32 s27, 0x20000
    s_mov_b64 s[16:17], s[70:71]
    s_mov_b32 s18, 1835008
    s_mov_b32 s19, 0x20000
    v_lshlrev_b32 v52, 1, v49
    v_xor_b32 v52, v52, v50
    v_lshlrev_b32 v52, 4, v52
    v_lshl_add_u32 v40, v48, 10, v52
    v_add_u32 v41, 7168, v40
    v_add_u32 v42, 14336, v40
    v_add_u32 v43, 21504, v40
    s_lshl_b32 s49, s42, 17
    s_lshl_b32 s45, s7, 7
    s_add_u32 s49, s49, s45
    s_lshl_b32 s45, s6, 15
    s_add_u32 s49, s49, s45
    s_xor_b32 s52, s49, 32768
    s_mov_b32 s28, 0
    s_add_u32 s29, s28, 1
    s_cmp_eq_u32 s29, 7
    s_cselect_b32 s29, 0, s29
    s_add_u32 s30, s29, 1
    s_cmp_eq_u32 s30, 7
    s_cselect_b32 s30, 0, s30
    s_add_u32 s31, s30, 1
    s_cmp_eq_u32 s31, 7
    s_cselect_b32 s31, 0, s31
    s_add_u32 s32, s31, 1
    s_cmp_eq_u32 s32, 7
    s_cselect_b32 s32, 0, s32
    s_add_u32 s33, s32, 1
    s_cmp_eq_u32 s33, 7
    s_cselect_b32 s33, 0, s33
    s_add_u32 s34, s33, 1
    s_cmp_eq_u32 s34, 7
    s_cselect_b32 s34, 0, s34
    s_lshl_b32 s28, s28, 18
    s_lshl_b32 s29, s29, 18
    s_lshl_b32 s30, s30, 18
    s_lshl_b32 s31, s31, 18
    s_lshl_b32 s32, s32, 18
    s_lshl_b32 s33, s33, 18
    s_lshl_b32 s34, s34, 18
    s_add_u32 m0, s53, 53248
    s_add_u32 s44, s44, 57344
    buffer_load_dwordx4 v36, s[12:15], s44 offen offset:0  lds
    buffer_load_dwordx4 v37, s[12:15], s44 offen offset:1024  lds
    buffer_load_dwordx4 v38, s[12:15], s44 offen offset:2048  lds
    buffer_load_dwordx4 v39, s[12:15], s44 offen offset:3072  lds
    s_lshl_b32 s43, s54, 7
    s_add_u32 m0, s53, 32768
    s_add_u32 s43, s43, s47
    buffer_load_dwordx4 v32, s[8:11], s43 offen offset:0  lds
    buffer_load_dwordx4 v33, s[8:11], s43 offen offset:1024  lds
    buffer_load_dwordx4 v34, s[8:11], s43 offen offset:2048  lds
    buffer_load_dwordx4 v35, s[8:11], s43 offen offset:3072  lds
    s_waitcnt vmcnt(12)
    s_barrier
    s_add_u32 s54, s54, 1
    s_and_b32 s54, s54, 7
    s_add_u32 m0, s53, 36864
    s_add_u32 s43, s43, 32768
    buffer_load_dwordx4 v32, s[8:11], s43 offen offset:0  lds
    buffer_load_dwordx4 v33, s[8:11], s43 offen offset:1024  lds
    buffer_load_dwordx4 v34, s[8:11], s43 offen offset:2048  lds
    buffer_load_dwordx4 v35, s[8:11], s43 offen offset:3072  lds
    s_mul_i32 s44, s54, 229376
    s_add_u32 m0, s53, 81920
    s_add_u32 s44, s44, s48
    buffer_load_dwordx4 v36, s[12:15], s44 offen offset:0  lds
    buffer_load_dwordx4 v37, s[12:15], s44 offen offset:1024  lds
    buffer_load_dwordx4 v38, s[12:15], s44 offen offset:2048  lds
    buffer_load_dwordx4 v39, s[12:15], s44 offen offset:3072  lds
    s_add_u32 m0, s53, 86016
    s_add_u32 s44, s44, 57344
    buffer_load_dwordx4 v36, s[12:15], s44 offen offset:0  lds
    buffer_load_dwordx4 v37, s[12:15], s44 offen offset:1024  lds
    buffer_load_dwordx4 v38, s[12:15], s44 offen offset:2048  lds
    buffer_load_dwordx4 v39, s[12:15], s44 offen offset:3072  lds
    s_lshl_b32 s43, s54, 7
    s_add_u32 m0, s53, 65536
    s_add_u32 s43, s43, s47
    buffer_load_dwordx4 v32, s[8:11], s43 offen offset:0  lds
    buffer_load_dwordx4 v33, s[8:11], s43 offen offset:1024  lds
    buffer_load_dwordx4 v34, s[8:11], s43 offen offset:2048  lds
    buffer_load_dwordx4 v35, s[8:11], s43 offen offset:3072  lds
    s_add_u32 s54, s54, 1
    s_and_b32 s54, s54, 7
    s_add_u32 m0, s53, 69632
    s_add_u32 s43, s43, 32768
    buffer_load_dwordx4 v32, s[8:11], s43 offen offset:0  lds
    buffer_load_dwordx4 v33, s[8:11], s43 offen offset:1024  lds
    buffer_load_dwordx4 v34, s[8:11], s43 offen offset:2048  lds
    buffer_load_dwordx4 v35, s[8:11], s43 offen offset:3072  lds
    s_mul_i32 s44, s54, 229376
    s_add_u32 m0, s53, 114688
    s_add_u32 s44, s44, s48
    buffer_load_dwordx4 v36, s[12:15], s44 offen offset:0  lds
    buffer_load_dwordx4 v37, s[12:15], s44 offen offset:1024  lds
    buffer_load_dwordx4 v38, s[12:15], s44 offen offset:2048  lds
    buffer_load_dwordx4 v39, s[12:15], s44 offen offset:3072  lds
    s_add_u32 m0, s53, 118784
    s_add_u32 s44, s44, 57344
    buffer_load_dwordx4 v36, s[12:15], s44 offen offset:0  lds
    buffer_load_dwordx4 v37, s[12:15], s44 offen offset:1024  lds
    buffer_load_dwordx4 v38, s[12:15], s44 offen offset:2048  lds
    buffer_load_dwordx4 v39, s[12:15], s44 offen offset:3072  lds
    s_waitcnt vmcnt(24)
    s_barrier
    s_lshl_b32 s43, s54, 7
    s_add_u32 m0, s53, 98304
    s_add_u32 s43, s43, s47
    buffer_load_dwordx4 v32, s[8:11], s43 offen offset:0  lds
    buffer_load_dwordx4 v33, s[8:11], s43 offen offset:1024  lds
    buffer_load_dwordx4 v34, s[8:11], s43 offen offset:2048  lds
    buffer_load_dwordx4 v35, s[8:11], s43 offen offset:3072  lds
    s_add_u32 s54, s54, 1
    s_and_b32 s54, s54, 7
    s_add_u32 m0, s53, 102400
    s_add_u32 s43, s43, 32768
    buffer_load_dwordx4 v32, s[8:11], s43 offen offset:0  lds
    buffer_load_dwordx4 v33, s[8:11], s43 offen offset:1024  lds
    buffer_load_dwordx4 v34, s[8:11], s43 offen offset:2048  lds
    buffer_load_dwordx4 v35, s[8:11], s43 offen offset:3072  lds
    s_mul_i32 s44, s54, 229376
    s_add_u32 m0, s53, 16384
    s_add_u32 s44, s44, s48
    buffer_load_dwordx4 v36, s[12:15], s44 offen offset:0  lds
    buffer_load_dwordx4 v37, s[12:15], s44 offen offset:1024  lds
    buffer_load_dwordx4 v38, s[12:15], s44 offen offset:2048  lds
    buffer_load_dwordx4 v39, s[12:15], s44 offen offset:3072  lds
    s_add_u32 m0, s53, 20480
    s_add_u32 s44, s44, 57344
    buffer_load_dwordx4 v36, s[12:15], s44 offen offset:0  lds
    buffer_load_dwordx4 v37, s[12:15], s44 offen offset:1024  lds
    buffer_load_dwordx4 v38, s[12:15], s44 offen offset:2048  lds
    buffer_load_dwordx4 v39, s[12:15], s44 offen offset:3072  lds
    s_waitcnt vmcnt(24)
    s_barrier
    s_lshl_b32 s43, s54, 7
    s_add_u32 m0, s53, 0
    s_add_u32 s43, s43, s47
    buffer_load_dwordx4 v32, s[8:11], s43 offen offset:0  lds
    buffer_load_dwordx4 v33, s[8:11], s43 offen offset:1024  lds
    buffer_load_dwordx4 v34, s[8:11], s43 offen offset:2048  lds
    buffer_load_dwordx4 v35, s[8:11], s43 offen offset:3072  lds
    s_add_u32 s54, s54, 1
    s_and_b32 s54, s54, 7
    s_add_u32 m0, s53, 4096
    s_add_u32 s43, s43, 32768
    buffer_load_dwordx4 v32, s[8:11], s43 offen offset:0  lds
    buffer_load_dwordx4 v33, s[8:11], s43 offen offset:1024  lds
    buffer_load_dwordx4 v34, s[8:11], s43 offen offset:2048  lds
    buffer_load_dwordx4 v35, s[8:11], s43 offen offset:3072  lds
    s_mul_i32 s44, s54, 229376
    s_add_u32 m0, s53, 49152
    s_add_u32 s44, s44, s48
    buffer_load_dwordx4 v36, s[12:15], s44 offen offset:0  lds
    buffer_load_dwordx4 v37, s[12:15], s44 offen offset:1024  lds
    buffer_load_dwordx4 v38, s[12:15], s44 offen offset:2048  lds
    buffer_load_dwordx4 v39, s[12:15], s44 offen offset:3072  lds
    s_add_u32 m0, s53, 53248
    s_add_u32 s44, s44, 57344
    buffer_load_dwordx4 v36, s[12:15], s44 offen offset:0  lds
    buffer_load_dwordx4 v37, s[12:15], s44 offen offset:1024  lds
    buffer_load_dwordx4 v38, s[12:15], s44 offen offset:2048  lds
    buffer_load_dwordx4 v39, s[12:15], s44 offen offset:3072  lds
    s_waitcnt vmcnt(24)
    s_barrier
    s_lshl_b32 s43, s54, 7
    s_add_u32 m0, s53, 32768
    s_add_u32 s43, s43, s47
    buffer_load_dwordx4 v32, s[8:11], s43 offen offset:0  lds
    buffer_load_dwordx4 v33, s[8:11], s43 offen offset:1024  lds
    buffer_load_dwordx4 v34, s[8:11], s43 offen offset:2048  lds
    buffer_load_dwordx4 v35, s[8:11], s43 offen offset:3072  lds
    s_add_u32 s54, s54, 1
    s_and_b32 s54, s54, 7
    s_add_u32 m0, s53, 36864
    s_add_u32 s43, s43, 32768
    buffer_load_dwordx4 v32, s[8:11], s43 offen offset:0  lds
    buffer_load_dwordx4 v33, s[8:11], s43 offen offset:1024  lds
    buffer_load_dwordx4 v34, s[8:11], s43 offen offset:2048  lds
    buffer_load_dwordx4 v35, s[8:11], s43 offen offset:3072  lds
    s_mul_i32 s44, s54, 229376
    s_add_u32 m0, s53, 81920
    s_add_u32 s44, s44, s48
    buffer_load_dwordx4 v36, s[12:15], s44 offen offset:0  lds
    buffer_load_dwordx4 v37, s[12:15], s44 offen offset:1024  lds
    buffer_load_dwordx4 v38, s[12:15], s44 offen offset:2048  lds
    buffer_load_dwordx4 v39, s[12:15], s44 offen offset:3072  lds
    s_add_u32 m0, s53, 86016
    s_add_u32 s44, s44, 57344
    buffer_load_dwordx4 v36, s[12:15], s44 offen offset:0  lds
    buffer_load_dwordx4 v37, s[12:15], s44 offen offset:1024  lds
    buffer_load_dwordx4 v38, s[12:15], s44 offen offset:2048  lds
    buffer_load_dwordx4 v39, s[12:15], s44 offen offset:3072  lds
    s_waitcnt vmcnt(24)
    s_barrier
    s_lshl_b32 s43, s54, 7
    s_add_u32 m0, s53, 65536
    s_add_u32 s43, s43, s47
    buffer_load_dwordx4 v32, s[8:11], s43 offen offset:0  lds
    buffer_load_dwordx4 v33, s[8:11], s43 offen offset:1024  lds
    buffer_load_dwordx4 v34, s[8:11], s43 offen offset:2048  lds
    buffer_load_dwordx4 v35, s[8:11], s43 offen offset:3072  lds
    s_add_u32 s54, s54, 1
    s_and_b32 s54, s54, 7
    s_add_u32 m0, s53, 69632
    s_add_u32 s43, s43, 32768
    buffer_load_dwordx4 v32, s[8:11], s43 offen offset:0  lds
    buffer_load_dwordx4 v33, s[8:11], s43 offen offset:1024  lds
    buffer_load_dwordx4 v34, s[8:11], s43 offen offset:2048  lds
    buffer_load_dwordx4 v35, s[8:11], s43 offen offset:3072  lds
    s_mul_i32 s44, s54, 229376
    s_add_u32 m0, s53, 114688
    s_add_u32 s44, s44, s48
    buffer_load_dwordx4 v36, s[12:15], s44 offen offset:0  lds
    buffer_load_dwordx4 v37, s[12:15], s44 offen offset:1024  lds
    buffer_load_dwordx4 v38, s[12:15], s44 offen offset:2048  lds
    buffer_load_dwordx4 v39, s[12:15], s44 offen offset:3072  lds
    s_add_u32 m0, s53, 118784
    s_add_u32 s44, s44, 57344
    buffer_load_dwordx4 v36, s[12:15], s44 offen offset:0  lds
    buffer_load_dwordx4 v37, s[12:15], s44 offen offset:1024  lds
    buffer_load_dwordx4 v38, s[12:15], s44 offen offset:2048  lds
    buffer_load_dwordx4 v39, s[12:15], s44 offen offset:3072  lds
    s_waitcnt vmcnt(24)
    s_barrier
    s_lshl_b32 s43, s54, 7
    s_add_u32 m0, s53, 98304
    s_add_u32 s43, s43, s47
    buffer_load_dwordx4 v32, s[8:11], s43 offen offset:0  lds
    buffer_load_dwordx4 v33, s[8:11], s43 offen offset:1024  lds
    buffer_load_dwordx4 v34, s[8:11], s43 offen offset:2048  lds
    buffer_load_dwordx4 v35, s[8:11], s43 offen offset:3072  lds
    s_add_u32 s54, s54, 1
    s_and_b32 s54, s54, 7
    s_add_u32 m0, s53, 102400
    s_add_u32 s43, s43, 32768
    buffer_load_dwordx4 v32, s[8:11], s43 offen offset:0  lds
    buffer_load_dwordx4 v33, s[8:11], s43 offen offset:1024  lds
    buffer_load_dwordx4 v34, s[8:11], s43 offen offset:2048  lds
    buffer_load_dwordx4 v35, s[8:11], s43 offen offset:3072  lds
    s_waitcnt vmcnt(16)
    s_barrier
    s_add_u32 m0, s53, 131072
    s_add_u32 s45, s49, s28
    buffer_load_dwordx4 v40, s[16:19], s45 offen offset:0  lds
    buffer_load_dwordx4 v41, s[16:19], s45 offen offset:1024  lds
    buffer_load_dwordx4 v42, s[16:19], s45 offen offset:2048  lds
    buffer_load_dwordx4 v43, s[16:19], s45 offen offset:3072  lds
    s_add_u32 m0, s53, 135168
    s_add_u32 s45, s45, 65536
    buffer_load_dwordx4 v40, s[16:19], s45 offen offset:0  lds
    buffer_load_dwordx4 v41, s[16:19], s45 offen offset:1024  lds
    buffer_load_dwordx4 v42, s[16:19], s45 offen offset:2048  lds
    buffer_load_dwordx4 v43, s[16:19], s45 offen offset:3072  lds
    s_add_u32 m0, s53, 0
    s_add_u32 s45, s49, s29
    buffer_load_dwordx4 v40, s[16:19], s45 offen offset:0  lds
    buffer_load_dwordx4 v41, s[16:19], s45 offen offset:1024  lds
    buffer_load_dwordx4 v42, s[16:19], s45 offen offset:2048  lds
    buffer_load_dwordx4 v43, s[16:19], s45 offen offset:3072  lds
    s_waitcnt vmcnt(12)
    s_barrier
    s_add_u32 m0, s53, 4096
    s_add_u32 s45, s45, 65536
    buffer_load_dwordx4 v40, s[16:19], s45 offen offset:0  lds
    buffer_load_dwordx4 v41, s[16:19], s45 offen offset:1024  lds
    buffer_load_dwordx4 v42, s[16:19], s45 offen offset:2048  lds
    buffer_load_dwordx4 v43, s[16:19], s45 offen offset:3072  lds
    s_add_u32 m0, s53, 16384
    s_add_u32 s45, s49, s30
    buffer_load_dwordx4 v40, s[16:19], s45 offen offset:0  lds
    buffer_load_dwordx4 v41, s[16:19], s45 offen offset:1024  lds
    buffer_load_dwordx4 v42, s[16:19], s45 offen offset:2048  lds
    buffer_load_dwordx4 v43, s[16:19], s45 offen offset:3072  lds
    s_add_u32 m0, s53, 20480
    s_add_u32 s45, s45, 65536
    buffer_load_dwordx4 v40, s[16:19], s45 offen offset:0  lds
    buffer_load_dwordx4 v41, s[16:19], s45 offen offset:1024  lds
    buffer_load_dwordx4 v42, s[16:19], s45 offen offset:2048  lds
    buffer_load_dwordx4 v43, s[16:19], s45 offen offset:3072  lds
    s_add_u32 m0, s53, 32768
    s_add_u32 s45, s49, s31
    buffer_load_dwordx4 v40, s[16:19], s45 offen offset:0  lds
    buffer_load_dwordx4 v41, s[16:19], s45 offen offset:1024  lds
    buffer_load_dwordx4 v42, s[16:19], s45 offen offset:2048  lds
    buffer_load_dwordx4 v43, s[16:19], s45 offen offset:3072  lds
    s_add_u32 m0, s53, 36864
    s_add_u32 s45, s45, 65536
    buffer_load_dwordx4 v40, s[16:19], s45 offen offset:0  lds
    buffer_load_dwordx4 v41, s[16:19], s45 offen offset:1024  lds
    buffer_load_dwordx4 v42, s[16:19], s45 offen offset:2048  lds
    buffer_load_dwordx4 v43, s[16:19], s45 offen offset:3072  lds
    s_waitcnt vmcnt(16)
    s_barrier
    s_add_u32 m0, s53, 49152
    s_add_u32 s45, s49, s32
    buffer_load_dwordx4 v40, s[16:19], s45 offen offset:0  lds
    buffer_load_dwordx4 v41, s[16:19], s45 offen offset:1024  lds
    buffer_load_dwordx4 v42, s[16:19], s45 offen offset:2048  lds
    buffer_load_dwordx4 v43, s[16:19], s45 offen offset:3072  lds
    s_add_u32 m0, s53, 53248
    s_add_u32 s45, s45, 65536
    buffer_load_dwordx4 v40, s[16:19], s45 offen offset:0  lds
    buffer_load_dwordx4 v41, s[16:19], s45 offen offset:1024  lds
    buffer_load_dwordx4 v42, s[16:19], s45 offen offset:2048  lds
    buffer_load_dwordx4 v43, s[16:19], s45 offen offset:3072  lds
    s_add_u32 m0, s53, 65536
    s_add_u32 s45, s49, s33
    buffer_load_dwordx4 v40, s[16:19], s45 offen offset:0  lds
    buffer_load_dwordx4 v41, s[16:19], s45 offen offset:1024  lds
    buffer_load_dwordx4 v42, s[16:19], s45 offen offset:2048  lds
    buffer_load_dwordx4 v43, s[16:19], s45 offen offset:3072  lds
    s_add_u32 m0, s53, 69632
    s_add_u32 s45, s45, 65536
    buffer_load_dwordx4 v40, s[16:19], s45 offen offset:0  lds
    buffer_load_dwordx4 v41, s[16:19], s45 offen offset:1024  lds
    buffer_load_dwordx4 v42, s[16:19], s45 offen offset:2048  lds
    buffer_load_dwordx4 v43, s[16:19], s45 offen offset:3072  lds
    s_add_u32 m0, s53, 81920
    s_add_u32 s45, s49, s34
    buffer_load_dwordx4 v40, s[16:19], s45 offen offset:0  lds
    buffer_load_dwordx4 v41, s[16:19], s45 offen offset:1024  lds
    buffer_load_dwordx4 v42, s[16:19], s45 offen offset:2048  lds
    buffer_load_dwordx4 v43, s[16:19], s45 offen offset:3072  lds
    s_add_u32 m0, s53, 86016
    s_add_u32 s45, s45, 65536
    buffer_load_dwordx4 v40, s[16:19], s45 offen offset:0  lds
    buffer_load_dwordx4 v41, s[16:19], s45 offen offset:1024  lds
    buffer_load_dwordx4 v42, s[16:19], s45 offen offset:2048  lds
    buffer_load_dwordx4 v43, s[16:19], s45 offen offset:3072  lds
    s_add_u32 m0, s53, 98304
    s_add_u32 s45, s52, s28
    buffer_load_dwordx4 v40, s[16:19], s45 offen offset:0  lds
    buffer_load_dwordx4 v41, s[16:19], s45 offen offset:1024  lds
    buffer_load_dwordx4 v42, s[16:19], s45 offen offset:2048  lds
    buffer_load_dwordx4 v43, s[16:19], s45 offen offset:3072  lds
    s_add_u32 m0, s53, 102400
    s_add_u32 s45, s45, 65536
    buffer_load_dwordx4 v40, s[16:19], s45 offen offset:0  lds
    buffer_load_dwordx4 v41, s[16:19], s45 offen offset:1024  lds
    buffer_load_dwordx4 v42, s[16:19], s45 offen offset:2048  lds
    buffer_load_dwordx4 v43, s[16:19], s45 offen offset:3072  lds
    s_add_u32 m0, s53, 114688
    s_add_u32 s45, s52, s29
    buffer_load_dwordx4 v40, s[16:19], s45 offen offset:0  lds
    buffer_load_dwordx4 v41, s[16:19], s45 offen offset:1024  lds
    buffer_load_dwordx4 v42, s[16:19], s45 offen offset:2048  lds
    buffer_load_dwordx4 v43, s[16:19], s45 offen offset:3072  lds
    s_add_u32 m0, s53, 118784
    s_add_u32 s45, s45, 65536
    buffer_load_dwordx4 v40, s[16:19], s45 offen offset:0  lds
    buffer_load_dwordx4 v41, s[16:19], s45 offen offset:1024  lds
    buffer_load_dwordx4 v42, s[16:19], s45 offen offset:2048  lds
    buffer_load_dwordx4 v43, s[16:19], s45 offen offset:3072  lds
    s_branch L_lpost
L_lspare:
    s_waitcnt lgkmcnt(0)
    s_mov_b32 s36, 0x7654f210
    s_mov_b32 s37, 0x3bdcea98
    s_lshl_b32 s7, s5, 2
    s_lshr_b64 s[36:37], s[36:37], s7
    s_bfe_u32 s6, s36, 0x10003
    s_and_b32 s7, s36, 7
    s_mov_b32 s55, 0xffff0000
    s_mov_b64 s[36:37], s[72:73]
    s_mov_b32 s38, 1024
    s_mov_b32 s39, 0x20000
    s_mov_b64 s[24:25], s[74:75]
    s_mov_b32 s26, 2097152
    s_mov_b32 s27, 0x20000
    s_mov_b64 s[16:17], s[70:71]
    s_mov_b32 s18, 1835008
    s_mov_b32 s19, 0x20000
    v_lshlrev_b32 v52, 1, v49
    v_xor_b32 v52, v52, v50
    v_lshlrev_b32 v52, 4, v52
    v_lshl_add_u32 v40, v48, 10, v52
    v_add_u32 v41, 7168, v40
    v_add_u32 v42, 14336, v40
    v_add_u32 v43, 21504, v40
    s_lshl_b32 s49, s42, 17
    s_lshl_b32 s45, s7, 7
    s_add_u32 s49, s49, s45
    s_lshl_b32 s45, s6, 15
    s_add_u32 s49, s49, s45
    s_xor_b32 s52, s49, 32768
    s_mov_b32 s28, 0
    s_add_u32 s29, s28, 1
    s_cmp_eq_u32 s29, 7
    s_cselect_b32 s29, 0, s29
    s_add_u32 s30, s29, 1
    s_cmp_eq_u32 s30, 7
    s_cselect_b32 s30, 0, s30
    s_add_u32 s31, s30, 1
    s_cmp_eq_u32 s31, 7
    s_cselect_b32 s31, 0, s31
    s_add_u32 s32, s31, 1
    s_cmp_eq_u32 s32, 7
    s_cselect_b32 s32, 0, s32
    s_add_u32 s33, s32, 1
    s_cmp_eq_u32 s33, 7
    s_cselect_b32 s33, 0, s33
    s_add_u32 s34, s33, 1
    s_cmp_eq_u32 s34, 7
    s_cselect_b32 s34, 0, s34
    s_lshl_b32 s28, s28, 18
    s_lshl_b32 s29, s29, 18
    s_lshl_b32 s30, s30, 18
    s_lshl_b32 s31, s31, 18
    s_lshl_b32 s32, s32, 18
    s_lshl_b32 s33, s33, 18
    s_lshl_b32 s34, s34, 18
    v_lshlrev_b32 v46, 4, v0
    s_lshl_b32 s43, s4, 1
    s_add_u32 s43, s43, s5
    s_sub_u32 s43, s43, 14
    s_lshl_b32 s43, s43, 1
    s_add_u32 s43, s43, s42
    s_mul_i32 s43, s43, 28672
    s_mov_b32 s44, 7
L_gpf:
    buffer_load_dwordx4 v[64:67], v46, s[16:19], s43 offen
    buffer_load_dwordx4 v[68:71], v46, s[16:19], s43 offen offset:1024
    buffer_load_dwordx4 v[72:75], v46, s[16:19], s43 offen offset:2048
    buffer_load_dwordx4 v[76:79], v46, s[16:19], s43 offen offset:3072
    s_add_u32 s43, s43, 4096
    s_sub_u32 s44, s44, 1
    s_cmp_lg_u32 s44, 0
    s_cbranch_scc1 L_gpf
    s_and_b32 s43, s4, 1
    s_lshl_b32 s43, s43, 1
    s_add_u32 s43, s43, s5
    s_sub_u32 s43, s43, 14
    s_lshl_b32 s43, s43, 1
    s_add_u32 s43, s43, s42
    s_lshl_b32 s46, s43, 15
    v_lshrrev_b32 v47, 3, v0
    v_cmp_eq_u32 vcc, 7, v47
    s_nop 1
    v_cndmask_b32 v47, v47, 3, vcc
    v_mov_b32 v47, 0
    v_lshlrev_b32 v46, 4, v0
    v_lshl_add_u32 v46, v47, 18, v46
    s_mov_b32 s43, s46
    s_mov_b32 s44, 8
L_spf0:
    buffer_load_dwordx4 v[64:67], v46, s[16:19], s43 offen
    buffer_load_dwordx4 v[68:71], v46, s[16:19], s43 offen offset:1024
    buffer_load_dwordx4 v[72:75], v46, s[16:19], s43 offen offset:2048
    buffer_load_dwordx4 v[76:79], v46, s[16:19], s43 offen offset:3072
    s_add_u32 s43, s43, 4096
    s_sub_u32 s44, s44, 1
    s_cmp_lg_u32 s44, 0
    s_cbranch_scc1 L_spf0
    v_add_u32 v47, 1, v47
    v_cmp_eq_u32 vcc, 7, v47
    s_nop 1
    v_cndmask_b32 v47, v47, 0, vcc
    v_lshlrev_b32 v46, 4, v0
    v_lshl_add_u32 v46, v47, 18, v46
    s_mov_b32 s43, s46
    s_mov_b32 s44, 8
L_spf1:
    buffer_load_dwordx4 v[64:67], v46, s[16:19], s43 offen
    buffer_load_dwordx4 v[68:71], v46, s[16:19], s43 offen offset:1024
    buffer_load_dwordx4 v[72:75], v46, s[16:19], s43 offen offset:2048
    buffer_load_dwordx4 v[76:79], v46, s[16:19], s43 offen offset:3072
    s_add_u32 s43, s43, 4096
    s_sub_u32 s44, s44, 1
    s_cmp_lg_u32 s44, 0
    s_cbranch_scc1 L_spf1
    v_add_u32 v47, 1, v47
    v_cmp_eq_u32 vcc, 7, v47
    s_nop 1
    v_cndmask_b32 v47, v47, 0, vcc
    s_add_u32 m0, s53, 131072
    s_add_u32 s45, s49, s28
    buffer_load_dwordx4 v40, s[16:19], s45 offen offset:0  lds
    buffer_load_dwordx4 v41, s[16:19], s45 offen offset:1024  lds
    buffer_load_dwordx4 v42, s[16:19], s45 offen offset:2048  lds
    buffer_load_dwordx4 v43, s[16:19], s45 offen offset:3072  lds
    s_add_u32 m0, s53, 135168
    s_add_u32 s45, s45, 65536
    buffer_load_dwordx4 v40, s[16:19], s45 offen offset:0  lds
    buffer_load_dwordx4 v41, s[16:19], s45 offen offset:1024  lds
    buffer_load_dwordx4 v42, s[16:19], s45 offen offset:2048  lds
    buffer_load_dwordx4 v43, s[16:19], s45 offen offset:3072  lds
    s_add_u32 m0, s53, 0
    s_add_u32 s45, s49, s29
    buffer_load_dwordx4 v40, s[16:19], s45 offen offset:0  lds
    buffer_load_dwordx4 v41, s[16:19], s45 offen offset:1024  lds
    buffer_load_dwordx4 v42, s[16:19], s45 offen offset:2048  lds
    buffer_load_dwordx4 v43, s[16:19], s45 offen offset:3072  lds
    s_add_u32 m0, s53, 4096
    s_add_u32 s45, s45, 65536
    buffer_load_dwordx4 v40, s[16:19], s45 offen offset:0  lds
    buffer_load_dwordx4 v41, s[16:19], s45 offen offset:1024  lds
    buffer_load_dwordx4 v42, s[16:19], s45 offen offset:2048  lds
    buffer_load_dwordx4 v43, s[16:19], s45 offen offset:3072  lds
    s_add_u32 m0, s53, 16384
    s_add_u32 s45, s49, s30
    buffer_load_dwordx4 v40, s[16:19], s45 offen offset:0  lds
    buffer_load_dwordx4 v41, s[16:19], s45 offen offset:1024  lds
    buffer_load_dwordx4 v42, s[16:19], s45 offen offset:2048  lds
    buffer_load_dwordx4 v43, s[16:19], s45 offen offset:3072  lds
    s_add_u32 m0, s53, 20480
    s_add_u32 s45, s45, 65536
    buffer_load_dwordx4 v40, s[16:19], s45 offen offset:0  lds
    buffer_load_dwordx4 v41, s[16:19], s45 offen offset:1024  lds
    buffer_load_dwordx4 v42, s[16:19], s45 offen offset:2048  lds
    buffer_load_dwordx4 v43, s[16:19], s45 offen offset:3072  lds
    s_add_u32 m0, s53, 32768
    s_add_u32 s45, s49, s31
    buffer_load_dwordx4 v40, s[16:19], s45 offen offset:0  lds
    buffer_load_dwordx4 v41, s[16:19], s45 offen offset:1024  lds
    buffer_load_dwordx4 v42, s[16:19], s45 offen offset:2048  lds
    buffer_load_dwordx4 v43, s[16:19], s45 offen offset:3072  lds
    s_add_u32 m0, s53, 36864
    s_add_u32 s45, s45, 65536
    buffer_load_dwordx4 v40, s[16:19], s45 offen offset:0  lds
    buffer_load_dwordx4 v41, s[16:19], s45 offen offset:1024  lds
    buffer_load_dwordx4 v42, s[16:19], s45 offen offset:2048  lds
    buffer_load_dwordx4 v43, s[16:19], s45 offen offset:3072  lds
    s_add_u32 m0, s53, 49152
    s_add_u32 s45, s49, s32
    buffer_load_dwordx4 v40, s[16:19], s45 offen offset:0  lds
    buffer_load_dwordx4 v41, s[16:19], s45 offen offset:1024  lds
    buffer_load_dwordx4 v42, s[16:19], s45 offen offset:2048  lds
    buffer_load_dwordx4 v43, s[16:19], s45 offen offset:3072  lds
    s_add_u32 m0, s53, 53248
    s_add_u32 s45, s45, 65536
    buffer_load_dwordx4 v40, s[16:19], s45 offen offset:0  lds
    buffer_load_dwordx4 v41, s[16:19], s45 offen offset:1024  lds
    buffer_load_dwordx4 v42, s[16:19], s45 offen offset:2048  lds
    buffer_load_dwordx4 v43, s[16:19], s45 offen offset:3072  lds
    s_add_u32 m0, s53, 65536
    s_add_u32 s45, s49, s33
    buffer_load_dwordx4 v40, s[16:19], s45 offen offset:0  lds
    buffer_load_dwordx4 v41, s[16:19], s45 offen offset:1024  lds
    buffer_load_dwordx4 v42, s[16:19], s45 offen offset:2048  lds
    buffer_load_dwordx4 v43, s[16:19], s45 offen offset:3072  lds
    s_add_u32 m0, s53, 69632
    s_add_u32 s45, s45, 65536
    buffer_load_dwordx4 v40, s[16:19], s45 offen offset:0  lds
    buffer_load_dwordx4 v41, s[16:19], s45 offen offset:1024  lds
    buffer_load_dwordx4 v42, s[16:19], s45 offen offset:2048  lds
    buffer_load_dwordx4 v43, s[16:19], s45 offen offset:3072  lds
    s_add_u32 m0, s53, 81920
    s_add_u32 s45, s49, s34
    buffer_load_dwordx4 v40, s[16:19], s45 offen offset:0  lds
    buffer_load_dwordx4 v41, s[16:19], s45 offen offset:1024  lds
    buffer_load_dwordx4 v42, s[16:19], s45 offen offset:2048  lds
    buffer_load_dwordx4 v43, s[16:19], s45 offen offset:3072  lds
    s_add_u32 m0, s53, 86016
    s_add_u32 s45, s45, 65536
    buffer_load_dwordx4 v40, s[16:19], s45 offen offset:0  lds
    buffer_load_dwordx4 v41, s[16:19], s45 offen offset:1024  lds
    buffer_load_dwordx4 v42, s[16:19], s45 offen offset:2048  lds
    buffer_load_dwordx4 v43, s[16:19], s45 offen offset:3072  lds
    s_add_u32 m0, s53, 98304
    s_add_u32 s45, s52, s28
    buffer_load_dwordx4 v40, s[16:19], s45 offen offset:0  lds
    buffer_load_dwordx4 v41, s[16:19], s45 offen offset:1024  lds
    buffer_load_dwordx4 v42, s[16:19], s45 offen offset:2048  lds
    buffer_load_dwordx4 v43, s[16:19], s45 offen offset:3072  lds
    s_add_u32 m0, s53, 102400
    s_add_u32 s45, s45, 65536
    buffer_load_dwordx4 v40, s[16:19], s45 offen offset:0  lds
    buffer_load_dwordx4 v41, s[16:19], s45 offen offset:1024  lds
    buffer_load_dwordx4 v42, s[16:19], s45 offen offset:2048  lds
    buffer_load_dwordx4 v43, s[16:19], s45 offen offset:3072  lds
    s_add_u32 m0, s53, 114688
    s_add_u32 s45, s52, s29
    buffer_load_dwordx4 v40, s[16:19], s45 offen offset:0  lds
    buffer_load_dwordx4 v41, s[16:19], s45 offen offset:1024  lds
    buffer_load_dwordx4 v42, s[16:19], s45 offen offset:2048  lds
    buffer_load_dwordx4 v43, s[16:19], s45 offen offset:3072  lds
    s_add_u32 m0, s53, 118784
    s_add_u32 s45, s45, 65536
    buffer_load_dwordx4 v40, s[16:19], s45 offen offset:0  lds
    buffer_load_dwordx4 v41, s[16:19], s45 offen offset:1024  lds
    buffer_load_dwordx4 v42, s[16:19], s45 offen offset:2048  lds
    buffer_load_dwordx4 v43, s[16:19], s45 offen offset:3072  lds
    s_waitcnt vmcnt(56)
    s_barrier
L_lpost:
    v_and_b32 v6, 7, v0
    v_lshlrev_b32 v6, 4, v6
    s_lshl_b32 s43, s7, 7
    buffer_load_dwordx4 v[2:5], v6, s[36:39], s43 offen
    s_waitcnt vmcnt(41)
    s_barrier
    s_add_u32 m0, s53, 131072
    s_add_u32 s45, s52, s30
    buffer_load_dwordx4 v40, s[16:19], s45 offen offset:0  lds
    buffer_load_dwordx4 v41, s[16:19], s45 offen offset:1024  lds
    buffer_load_dwordx4 v42, s[16:19], s45 offen offset:2048  lds
    buffer_load_dwordx4 v43, s[16:19], s45 offen offset:3072  lds
    s_add_u32 m0, s53, 135168
    s_add_u32 s45, s45, 65536
    buffer_load_dwordx4 v40, s[16:19], s45 offen offset:0  lds
    buffer_load_dwordx4 v41, s[16:19], s45 offen offset:1024  lds
    buffer_load_dwordx4 v42, s[16:19], s45 offen offset:2048  lds
    buffer_load_dwordx4 v43, s[16:19], s45 offen offset:3072  lds
    s_add_u32 m0, s53, 0
    s_add_u32 s45, s52, s31
    buffer_load_dwordx4 v40, s[16:19], s45 offen offset:0  lds
    buffer_load_dwordx4 v41, s[16:19], s45 offen offset:1024  lds
    buffer_load_dwordx4 v42, s[16:19], s45 offen offset:2048  lds
    buffer_load_dwordx4 v43, s[16:19], s45 offen offset:3072  lds
    s_add_u32 m0, s53, 4096
    s_add_u32 s45, s45, 65536
    buffer_load_dwordx4 v40, s[16:19], s45 offen offset:0  lds
    buffer_load_dwordx4 v41, s[16:19], s45 offen offset:1024  lds
    buffer_load_dwordx4 v42, s[16:19], s45 offen offset:2048  lds
    buffer_load_dwordx4 v43, s[16:19], s45 offen offset:3072  lds
    s_add_u32 s45, s52, s32
    buffer_load_dwordx4 v[128:131], v40, s[16:19], s45 offen offset:0
    buffer_load_dwordx4 v[132:135], v41, s[16:19], s45 offen offset:1024
    buffer_load_dwordx4 v[136:139], v42, s[16:19], s45 offen offset:2048
    buffer_load_dwordx4 v[140:143], v43, s[16:19], s45 offen offset:3072
    s_add_u32 s45, s45, 65536
    buffer_load_dwordx4 v[144:147], v40, s[16:19], s45 offen offset:0
    buffer_load_dwordx4 v[148:151], v41, s[16:19], s45 offen offset:1024
    buffer_load_dwordx4 v[152:155], v42, s[16:19], s45 offen offset:2048
    buffer_load_dwordx4 v[156:159], v43, s[16:19], s45 offen offset:3072
    s_add_u32 s45, s52, s33
    buffer_load_dwordx4 v[160:163], v40, s[16:19], s45 offen offset:0
    buffer_load_dwordx4 v[164:167], v41, s[16:19], s45 offen offset:1024
    buffer_load_dwordx4 v[168:171], v42, s[16:19], s45 offen offset:2048
    buffer_load_dwordx4 v[172:175], v43, s[16:19], s45 offen offset:3072
    s_add_u32 s45, s45, 65536
    buffer_load_dwordx4 v[176:179], v40, s[16:19], s45 offen offset:0
    buffer_load_dwordx4 v[180:183], v41, s[16:19], s45 offen offset:1024
    buffer_load_dwordx4 v[184:187], v42, s[16:19], s45 offen offset:2048
    buffer_load_dwordx4 v[188:191], v43, s[16:19], s45 offen offset:3072
    s_add_u32 s45, s52, s34
    buffer_load_dwordx4 v[192:195], v40, s[16:19], s45 offen offset:0
    buffer_load_dwordx4 v[196:199], v41, s[16:19], s45 offen offset:1024
    buffer_load_dwordx4 v[200:203], v42, s[16:19], s45 offen offset:2048
    buffer_load_dwordx4 v[204:207], v43, s[16:19], s45 offen offset:3072
    s_add_u32 s45, s45, 65536
    buffer_load_dwordx4 v[208:211], v40, s[16:19], s45 offen offset:0
    buffer_load_dwordx4 v[212:215], v41, s[16:19], s45 offen offset:1024
    buffer_load_dwordx4 v[216:219], v42, s[16:19], s45 offen offset:2048
    buffer_load_dwordx4 v[220:223], v43, s[16:19], s45 offen offset:3072
    v_lshlrev_b32 v44, 4, v0
    v_add_u32 v44, s53, v44
    v_add_u32 v45, 147456, v44
    s_waitcnt vmcnt(40)
    v_lshlrev_b32 v20, 16, v2
    v_and_b32 v21, s55, v2
    v_lshlrev_b32 v22, 16, v3
    v_and_b32 v23, s55, v3
    v_lshlrev_b32 v24, 16, v4
    v_and_b32 v25, s55, v4
    v_lshlrev_b32 v26, 16, v5
    v_and_b32 v27, s55, v5
    v_lshrrev_b32 v29, 3, v0
    s_lshl_b32 s43, s3, 3
    v_add_u32 v29, s43, v29
    v_lshl_add_u32 v30, v29, 10, v6
    v_and_b32 v28, 7, v0
    v_lshlrev_b32 v28, 1, v28
    v_and_b32 v2, 15, v29
    v_xor_b32 v28, v28, v2
    v_lshlrev_b32 v28, 4, v28
    v_lshl_add_u32 v28, v29, 8, v28
    v_add_u32 v28, 49152, v28
    v_xor_b32 v29, 16, v28
    s_lshl_b32 s47, s4, 17
    s_lshl_b32 s44, s6, 16
    s_add_u32 s47, s47, s44
    s_lshl_b32 s44, s7, 7
    s_add_u32 s47, s47, s44
    s_barrier
    s_waitcnt vmcnt(16)
    ds_write_b128 v44, v[128:131] offset:16384
    ds_write_b128 v44, v[132:135] offset:17408
    ds_write_b128 v44, v[136:139] offset:18432
    ds_write_b128 v44, v[140:143] offset:19456
    ds_write_b128 v44, v[144:147] offset:20480
    ds_write_b128 v44, v[148:151] offset:21504
    ds_write_b128 v44, v[152:155] offset:22528
    ds_write_b128 v44, v[156:159] offset:23552
    s_waitcnt vmcnt(8)
    ds_write_b128 v44, v[160:163] offset:32768
    ds_write_b128 v44, v[164:167] offset:33792
    ds_write_b128 v44, v[168:171] offset:34816
    ds_write_b128 v44, v[172:175] offset:35840
    ds_write_b128 v44, v[176:179] offset:36864
    ds_write_b128 v44, v[180:183] offset:37888
    ds_write_b128 v44, v[184:187] offset:38912
    ds_write_b128 v44, v[188:191] offset:39936
    s_waitcnt vmcnt(0)
    ds_write_b128 v45, v[192:195] offset:0
    ds_write_b128 v45, v[196:199] offset:1024
    ds_write_b128 v45, v[200:203] offset:2048
    ds_write_b128 v45, v[204:207] offset:3072
    ds_write_b128 v45, v[208:211] offset:4096
    ds_write_b128 v45, v[212:215] offset:5120
    ds_write_b128 v45, v[216:219] offset:6144
    ds_write_b128 v45, v[220:223] offset:7168
    s_waitcnt vmcnt(0) lgkmcnt(0)
    s_barrier
    s_branch L_final
L_serv:
    s_sub_u32 s42, s3, 6
    v_lshrrev_b32 v52, 4, v0
    v_and_b32 v53, 15, v0
    v_lshlrev_b32 v53, 4, v53
    v_lshl_add_u32 v53, v52, 10, v53
    s_lshl_b32 s43, s4, 17
    s_lshl_b32 s44, s5, 13
    s_add_u32 s46, s43, s44
    s_lshl_b32 s44, s42, 12
    s_add_u32 s46, s46, s44
    s_lshl_b32 s44, s4, 4
    v_mov_b32 v17, s44
    s_mov_b32 s30, 256
    s_mov_b32 s31, 0x20000
    s_add_u32 s45, s5, s42
    s_waitcnt lgkmcnt(0)
    s_mov_b64 s[8:9], s[64:65]
    s_mov_b64 s[28:29], s[76:77]
    s_cmp_lg_u32 s45, 0
    s_cbranch_scc1 L_s_nolead
    s_lshl_b32 s44, s62, 4
    s_or_b32 s44, s44, 8
    v_mov_b32 v54, s44
    s_mov_b64 exec, 1
    buffer_store_dword v54, v17, s[28:31], 0 offen sc1
    s_mov_b64 exec, -1
L_s_nolead:
    buffer_load_dwordx4 v[64:67], v53, s[8:11], s46 offen offset:0
    buffer_load_dwordx4 v[68:71], v53, s[8:11], s46 offen offset:256
    buffer_load_dwordx4 v[72:75], v53, s[8:11], s46 offen offset:512
    buffer_load_dwordx4 v[76:79], v53, s[8:11], s46 offen offset:768
    s_mov_b32 s36, 0x7654f210
    s_mov_b32 s37, 0x3bdcea98
    s_lshl_b32 s7, s5, 2
    s_lshr_b64 s[36:37], s[36:37], s7
    s_bfe_u32 s6, s36, 0x10003
    s_and_b32 s7, s36, 7
    s_mov_b32 s55, 0xffff0000
    s_mov_b64 s[36:37], s[72:73]
    s_mov_b32 s38, 1024
    s_mov_b32 s39, 0x20000
    s_mov_b64 s[24:25], s[74:75]
    s_mov_b32 s26, 2097152
    s_mov_b32 s27, 0x20000
    s_add_u32 s20, s78, 0
    s_addc_u32 s21, s79, 0
    s_mov_b32 s22, 16777216
    s_mov_b32 s23, 0x20000
    s_getreg_b32 s41, hwreg(HW_REG_XCC_ID, 0, 3)
    s_lshl_b32 s50, s4, 19
    s_add_u32 s50, s50, 458752
    s_mov_b32 s57, 0x40000
    s_lshl_b32 s43, s5, 6
    s_lshl_b32 s44, s42, 5
    s_add_u32 s43, s43, s44
    s_add_u32 s43, s43, 1024
    v_lshlrev_b32 v55, 3, v52
    v_add_u32 v55, s43, v55
    v_lshlrev_b32 v56, 4, v0
    s_add_u32 s46, s50, 1024
    v_add_u32 v57, 147456, v56
    s_mov_b32 m0, 147456
    v_mov_b32 v80, 0
    v_mov_b32 v81, 0
    v_mov_b32 v82, 0
    v_mov_b32 v83, 0
    v_mov_b32 v84, 0
    v_mov_b32 v85, 0
    v_mov_b32 v86, 0
    v_mov_b32 v87, 0
    s_cmp_ge_u32 s5, 14
    s_cbranch_scc1 L_sb_1
    s_barrier
L_sb_1:
    s_waitcnt vmcnt(0)
    buffer_load_dword v12, v17, s[28:31], 0 offen sc1
    v_mov_b32_dpp v61, v64 row_newbcast:0 row_mask:0xf bank_mask:0xf
    v_lshlrev_b32 v61, 16, v61
    v_lshlrev_b32 v58, 16, v64
    v_and_b32 v59, s55, v64
    v_sub_f32 v58, v58, v61
    v_sub_f32 v59, v59, v61
    v_add_f32 v80, v80, v58
    v_fmac_f32 v84, v58, v58
    v_add_f32 v82, v82, v59
    v_fmac_f32 v86, v59, v59
    v_lshlrev_b32 v58, 16, v65
    v_and_b32 v59, s55, v65
    v_sub_f32 v58, v58, v61
    v_sub_f32 v59, v59, v61
    v_add_f32 v81, v81, v58
    v_fmac_f32 v85, v58, v58
    v_add_f32 v83, v83, v59
    v_fmac_f32 v87, v59, v59
    v_lshlrev_b32 v58, 16, v66
    v_and_b32 v59, s55, v66
    v_sub_f32 v58, v58, v61
    v_sub_f32 v59, v59, v61
    v_add_f32 v80, v80, v58
    v_fmac_f32 v84, v58, v58
    v_add_f32 v82, v82, v59
    v_fmac_f32 v86, v59, v59
    v_lshlrev_b32 v58, 16, v67
    v_and_b32 v59, s55, v67
    v_sub_f32 v58, v58, v61
    v_sub_f32 v59, v59, v61
    v_add_f32 v81, v81, v58
    v_fmac_f32 v85, v58, v58
    v_add_f32 v83, v83, v59
    v_fmac_f32 v87, v59, v59
    v_lshlrev_b32 v58, 16, v68
    v_and_b32 v59, s55, v68
    v_sub_f32 v58, v58, v61
    v_sub_f32 v59, v59, v61
    v_add_f32 v80, v80, v58
    v_fmac_f32 v84, v58, v58
    v_add_f32 v82, v82, v59
    v_fmac_f32 v86, v59, v59
    v_lshlrev_b32 v58, 16, v69
    v_and_b32 v59, s55, v69
    v_sub_f32 v58, v58, v61
    v_sub_f32 v59, v59, v61
    v_add_f32 v81, v81, v58
    v_fmac_f32 v85, v58, v58
    v_add_f32 v83, v83, v59
    v_fmac_f32 v87, v59, v59
    v_lshlrev_b32 v58, 16, v70
    v_and_b32 v59, s55, v70
    v_sub_f32 v58, v58, v61
    v_sub_f32 v59, v59, v61
    v_add_f32 v80, v80, v58
    v_fmac_f32 v84, v58, v58
    v_add_f32 v82, v82, v59
    v_fmac_f32 v86, v59, v59
    v_lshlrev_b32 v58, 16, v71
    v_and_b32 v59, s55, v71
    v_sub_f32 v58, v58, v61
    v_sub_f32 v59, v59, v61
    v_add_f32 v81, v81, v58
    v_fmac_f32 v85, v58, v58
    v_add_f32 v83, v83, v59
    v_fmac_f32 v87, v59, v59
    s_cmp_ge_u32 s5, 14
    s_cbranch_scc1 L_sb_2
    s_barrier
L_sb_2:
    v_lshlrev_b32 v58, 16, v72
    v_and_b32 v59, s55, v72
    v_sub_f32 v58, v58, v61
    v_sub_f32 v59, v59, v61
    v_add_f32 v80, v80, v58
    v_fmac_f32 v84, v58, v58
    v_add_f32 v82, v82, v59
    v_fmac_f32 v86, v59, v59
    v_lshlrev_b32 v58, 16, v73
    v_and_b32 v59, s55, v73
    v_sub_f32 v58, v58, v61
    v_sub_f32 v59, v59, v61
    v_add_f32 v81, v81, v58
    v_fmac_f32 v85, v58, v58
    v_add_f32 v83, v83, v59
    v_fmac_f32 v87, v59, v59
    v_lshlrev_b32 v58, 16, v74
    v_and_b32 v59, s55, v74
    v_sub_f32 v58, v58, v61
    v_sub_f32 v59, v59, v61
    v_add_f32 v80, v80, v58
    v_fmac_f32 v84, v58, v58
    v_add_f32 v82, v82, v59
    v_fmac_f32 v86, v59, v59
    v_lshlrev_b32 v58, 16, v75
    v_and_b32 v59, s55, v75
    v_sub_f32 v58, v58, v61
    v_sub_f32 v59, v59, v61
    v_add_f32 v81, v81, v58
    v_fmac_f32 v85, v58, v58
    v_add_f32 v83, v83, v59
    v_fmac_f32 v87, v59, v59
    v_lshlrev_b32 v58, 16, v76
    v_and_b32 v59, s55, v76
    v_sub_f32 v58, v58, v61
    v_sub_f32 v59, v59, v61
    v_add_f32 v80, v80, v58
    v_fmac_f32 v84, v58, v58
    v_add_f32 v82, v82, v59
    v_fmac_f32 v86, v59, v59
    v_lshlrev_b32 v58, 16, v77
    v_and_b32 v59, s55, v77
    v_sub_f32 v58, v58, v61
    v_sub_f32 v59, v59, v61
    v_add_f32 v81, v81, v58
    v_fmac_f32 v85, v58, v58
    v_add_f32 v83, v83, v59
    v_fmac_f32 v87, v59, v59
    v_lshlrev_b32 v58, 16, v78
    v_and_b32 v59, s55, v78
    v_sub_f32 v58, v58, v61
    v_sub_f32 v59, v59, v61
    v_add_f32 v80, v80, v58
    v_fmac_f32 v84, v58, v58
    v_add_f32 v82, v82, v59
    v_fmac_f32 v86, v59, v59
    v_lshlrev_b32 v58, 16, v79
    v_and_b32 v59, s55, v79
    v_sub_f32 v58, v58, v61
    v_sub_f32 v59, v59, v61
    v_add_f32 v81, v81, v58
    v_fmac_f32 v85, v58, v58
    v_add_f32 v83, v83, v59
    v_fmac_f32 v87, v59, v59
    v_add_f32 v80, v80, v81
    v_add_f32 v82, v82, v83
    v_add_f32 v84, v84, v85
    v_add_f32 v86, v86, v87
    v_add_f32 v80, v80, v82
    v_add_f32 v84, v84, v86
    s_nop 1
    v_add_f32_dpp v80, v80, v80 quad_perm:[1,0,3,2] row_mask:0xf bank_mask:0xf
    v_add_f32_dpp v84, v84, v84 quad_perm:[1,0,3,2] row_mask:0xf bank_mask:0xf
    s_nop 1
    v_add_f32_dpp v80, v80, v80 quad_perm:[2,3,0,1] row_mask:0xf bank_mask:0xf
    v_add_f32_dpp v84, v84, v84 quad_perm:[2,3,0,1] row_mask:0xf bank_mask:0xf
    s_nop 1
    v_add_f32_dpp v80, v80, v80 row_half_mirror row_mask:0xf bank_mask:0xf
    v_add_f32_dpp v84, v84, v84 row_half_mirror row_mask:0xf bank_mask:0xf
    s_nop 1
    v_add_f32_dpp v80, v80, v80 row_mirror row_mask:0xf bank_mask:0xf
    v_add_f32_dpp v84, v84, v84 row_mirror row_mask:0xf bank_mask:0xf
    s_nop 1
    v_mul_f32 v80, 0x3b000000, v80
    v_mul_f32 v84, 0x3b000000, v84
    v_fma_f32 v84, -v80, v80, v84
    v_add_f32 v80, v80, v61
    v_max_f32 v84, 0, v84
    v_cvt_pk_bf16_f32 v84, v84, v84
    v_and_b32 v84, s55, v84
    v_add_f32 v84, 0x3727c5ac, v84
    v_cvt_pk_bf16_f32 v84, v84, v84
    v_and_b32 v84, s55, v84
    v_sqrt_f32 v84, v84
    s_nop 0
    v_cvt_pk_bf16_f32 v80, -v80, v84
    s_cmp_ge_u32 s5, 14
    s_cbranch_scc1 L_sb_3
    s_barrier
L_sb_3:
L_s_ep:
    s_waitcnt vmcnt(0)
    v_readfirstlane_b32 s60, v12
    s_cmp_lg_u32 s60, 0
    s_cbranch_scc1 L_s_ep2
    s_cmp_le_i32 s57, 0
    s_cbranch_scc1 L_s_ep2
    s_sub_u32 s57, s57, 1
    s_sleep 2
    buffer_load_dword v12, v17, s[28:31], 0 offen sc1
    s_branch L_s_ep
L_s_ep2:
    s_or_b32 s43, s60, s41
    v_mov_b32 v81, s43
    s_mov_b32 exec_lo, 0x00010001
    s_mov_b32 exec_hi, 0x00010001
    buffer_store_dwordx2 v[80:81], v55, s[20:23], s50 offen sc1
    s_mov_b64 exec, -1
    v_and_b32 v6, 7, v0
    v_lshlrev_b32 v6, 4, v6
    s_lshl_b32 s43, s7, 7
    buffer_load_dwordx4 v[2:5], v6, s[36:39], s43 offen
    s_cmp_ge_u32 s5, 14
    s_cbranch_scc1 L_s_g3
    s_barrier
    s_barrier
    s_cmp_eq_u32 s42, 1
    s_cbranch_scc1 L_s_g0
    buffer_load_dwordx4 v56, s[20:23], s46 offen sc1 lds
L_s_g0:
    s_barrier
    s_cmp_eq_u32 s42, 1
    s_cbranch_scc1 L_s_g2
L_s_g:
    s_waitcnt vmcnt(0)
    ds_read_b128 v[64:67], v57
    s_waitcnt lgkmcnt(0)
    v_xor_b32 v65, s60, v65
    v_xor_b32 v67, s60, v67
    v_or_b32 v65, v65, v67
    v_cmp_lt_u32 vcc, 7, v65
    s_cbranch_vccz L_s_g2
    s_cmp_le_i32 s57, 0
    s_cbranch_scc1 L_s_g2
    s_sub_u32 s57, s57, 1
    s_sleep 4
    buffer_load_dwordx4 v56, s[20:23], s46 offen sc1 lds
    s_branch L_s_g
L_s_g2:
    s_barrier
    s_barrier
L_s_g3:
    s_barrier
    s_waitcnt vmcnt(0) lgkmcnt(0)
    v_lshlrev_b32 v20, 16, v2
    v_and_b32 v21, s55, v2
    v_lshlrev_b32 v22, 16, v3
    v_and_b32 v23, s55, v3
    v_lshlrev_b32 v24, 16, v4
    v_and_b32 v25, s55, v4
    v_lshlrev_b32 v26, 16, v5
    v_and_b32 v27, s55, v5
    v_lshrrev_b32 v29, 3, v0
    s_lshl_b32 s43, s3, 3
    v_add_u32 v29, s43, v29
    v_lshl_add_u32 v30, v29, 10, v6
    v_and_b32 v28, 7, v0
    v_lshlrev_b32 v28, 1, v28
    v_and_b32 v2, 15, v29
    v_xor_b32 v28, v28, v2
    v_lshlrev_b32 v28, 4, v28
    v_lshl_add_u32 v28, v29, 8, v28
    v_add_u32 v28, 49152, v28
    v_xor_b32 v29, 16, v28
    s_lshl_b32 s47, s4, 17
    s_lshl_b32 s44, s6, 16
    s_add_u32 s47, s47, s44
    s_lshl_b32 s44, s7, 7
    s_add_u32 s47, s47, s44
    v_and_b32 v58, 15, v0
    v_min_u32 v58, 13, v58
    v_lshlrev_b32 v58, 2, v58
    v_and_b32 v59, 16, v0
    v_lshl_add_u32 v58, v59, 3, v58
    s_lshl_b32 s43, s6, 8
    v_add_u32 v58, s43, v58
    s_barrier
    s_cmp_eq_u32 s42, 1
    s_cbranch_scc1 L_sp_5
    buffer_load_dword v60, v58, s[20:23], s50 offen offset:0 sc1
    s_sleep 1
L_sp_4:
    buffer_load_dword v61, v58, s[20:23], s50 offen offset:0 sc1
    s_waitcnt vmcnt(1)
    v_cmp_ne_u32 vcc, s60, v60
    s_cbranch_vccz L_sp_5
    s_sleep 1
    buffer_load_dword v60, v58, s[20:23], s50 offen offset:0 sc1
    s_waitcnt vmcnt(1)
    v_cmp_ne_u32 vcc, s60, v61
    s_cbranch_vccz L_sp_5
    s_sleep 1
    s_cmp_le_i32 s57, 0
    s_cbranch_scc1 L_sp_5
    s_sub_u32 s57, s57, 1
    s_branch L_sp_4
L_sp_5:
    s_barrier
    s_cmp_eq_u32 s42, 1
    s_cbranch_scc1 L_sp_7
    buffer_load_dword v60, v58, s[20:23], s50 offen offset:64 sc1
    s_sleep 1
L_sp_6:
    buffer_load_dword v61, v58, s[20:23], s50 offen offset:64 sc1
    s_waitcnt vmcnt(1)
    v_cmp_ne_u32 vcc, s60, v60
    s_cbranch_vccz L_sp_7
    s_sleep 1
    buffer_load_dword v60, v58, s[20:23], s50 offen offset:64 sc1
    s_waitcnt vmcnt(1)
    v_cmp_ne_u32 vcc, s60, v61
    s_cbranch_vccz L_sp_7
    s_sleep 1
    s_cmp_le_i32 s57, 0
    s_cbranch_scc1 L_sp_7
    s_sub_u32 s57, s57, 1
    s_branch L_sp_6
L_sp_7:
    s_barrier
    s_cmp_lg_u32 s3, 7
    s_cbranch_scc1 L_nfc
    s_cmp_lt_u32 s5, 14
    s_cbranch_scc1 L_nfc
    v_lshlrev_b32 v59, 6, v0
    s_lshl_b32 s43, s6, 8
    v_add_u32 v59, s43, v59
    s_mov_b64 exec, 15
    buffer_store_dword v59, v59, s[20:23], s50 offen offset:60 sc1
    s_mov_b64 exec, -1
L_nfc:
    s_add_u32 s45, s5, s42
    s_cmp_lg_u32 s45, 0
    s_cbranch_scc1 L_final
    v_mov_b32 v54, 0
    s_mov_b64 exec, 1
    buffer_store_dword v54, v17, s[28:31], 0 offen sc1
    s_mov_b64 exec, -1
    s_branch L_final
L_comp:
    s_lshr_b32 s58, s3, 1
    s_and_b32 s59, s3, 1
    v_and_b32 v232, 15, v0
    v_lshrrev_b32 v233, 4, v0
    v_lshrrev_b32 v236, 1, v232
    v_xor_b32 v236, v236, v233
    v_lshlrev_b32 v236, 4, v236
    v_lshl_add_u32 v236, v232, 7, v236
    s_lshl_b32 s43, s58, 13
    v_add_u32 v2, s43, v236
    v_xor_b32 v3, 64, v2
    v_lshrrev_b32 v234, 2, v232
    v_and_b32 v235, 3, v232
    v_and_b32 v237, 1, v233
    v_lshl_or_b32 v237, v237, 2, v234
    v_lshl_add_u32 v238, v233, 3, v234
    v_lshlrev_b32 v238, 8, v238
    v_lshl_add_u32 v238, v235, 3, v238
    v_add_u32 v238, 16384, v238
    s_lshl_b32 s43, s59, 2
    s_lshl_b32 s44, s58, 1
    s_or_b32 s43, s43, s44
    v_xor_b32 v237, s43, v237
    v_lshl_add_u32 v4, v237, 5, v238
    v_xor_b32 v5, 32, v4
    v_xor_b32 v6, 64, v4
    v_xor_b32 v7, 96, v4
    s_mov_b32 s56, 0x3f803f80
    v_mov_b32 v12, s56
    v_mov_b32 v13, s56
    v_mov_b32 v14, s56
    v_mov_b32 v15, s56
    v_and_b32 v18, 1, v0
    v_mul_u32_u24 v18, 0xaaaa, v18
    v_add_u32 v18, 0x4444, v18
    v_lshl_or_b32 v18, v18, 16, v18
    v_mov_b32 v240, 0
    v_mov_b32 v241, 0
    v_mov_b32 v242, 0
    v_mov_b32 v243, 0
    v_mov_b32 v244, 0
    v_mov_b32 v245, 0
    v_mov_b32 v246, 0
    v_mov_b32 v247, 0
    s_waitcnt lgkmcnt(0)
    s_cmp_lt_u32 s5, 14
    s_cbranch_scc1 L_c_reg
    s_mov_b32 s36, 0x7654f210
    s_mov_b32 s37, 0x3bdcea98
    s_lshl_b32 s7, s5, 2
    s_lshr_b64 s[36:37], s[36:37], s7
    s_bfe_u32 s6, s36, 0x10003
    s_and_b32 s7, s36, 7
    s_mov_b32 s55, 0xffff0000
    s_mov_b64 s[36:37], s[72:73]
    s_mov_b32 s38, 1024
    s_mov_b32 s39, 0x20000
    s_mov_b64 s[24:25], s[74:75]
    s_mov_b32 s26, 2097152
    s_mov_b32 s27, 0x20000
    s_add_u32 s20, s78, 0
    s_addc_u32 s21, s79, 0
    s_mov_b32 s22, 16777216
    s_mov_b32 s23, 0x20000
    s_getreg_b32 s41, hwreg(HW_REG_XCC_ID, 0, 3)
    s_lshl_b32 s50, s4, 19
    s_add_u32 s50, s50, 458752
    v_lshlrev_b32 v11, 4, v0
    v_lshl_add_u32 v238, v233, 2, v234
    v_lshrrev_b32 v237, 1, v238
    v_and_b32 v237, 3, v237
    v_lshlrev_b32 v238, 7, v238
    v_lshl_add_u32 v238, v235, 3, v238
    v_lshl_add_u32 v238, v237, 5, v238
    s_lshl_b32 s43, s59, 12
    s_add_u32 s43, s43, 131072
    v_add_u32 v8, s43, v238
    v_xor_b32 v9, 32, v8
    v_xor_b32 v10, 64, v8
    s_lshl_b32 s51, s4, 19
    s_mul_i32 s43, s59, 57344
    s_add_u32 s51, s51, s43
    s_mul_i32 s43, s6, 229376
    s_add_u32 s61, s51, s43
    s_mul_i32 s43, s58, 114688
    s_add_u32 s61, s61, s43
    v_lshlrev_b32 v16, 8, v232
    v_xor_b32 v237, v233, v232
    v_lshl_add_u32 v16, v237, 4, v16
    s_lshl_b32 s43, s59, 14
    s_lshl_b32 s44, s58, 13
    s_add_u32 s43, s43, s44
    s_add_u32 s43, s43, 49152
    v_add_u32 v16, s43, v16
    s_mov_b32 s64, 0
    s_add_u32 s65, s64, 1
    s_cmp_eq_u32 s65, 7
    s_cselect_b32 s65, 0, s65
    s_add_u32 s66, s65, 1
    s_cmp_eq_u32 s66, 7
    s_cselect_b32 s66, 0, s66
    s_add_u32 s67, s66, 1
    s_cmp_eq_u32 s67, 7
    s_cselect_b32 s67, 0, s67
    s_add_u32 s68, s67, 1
    s_cmp_eq_u32 s68, 7
    s_cselect_b32 s68, 0, s68
    s_add_u32 s69, s68, 1
    s_cmp_eq_u32 s69, 7
    s_cselect_b32 s69, 0, s69
    s_add_u32 s70, s69, 1
    s_cmp_eq_u32 s70, 7
    s_cselect_b32 s70, 0, s70
    s_lshl_b32 s64, s64, 12
    s_lshl_b32 s65, s65, 12
    s_lshl_b32 s66, s66, 12
    s_lshl_b32 s67, s67, 12
    s_lshl_b32 s68, s68, 12
    s_lshl_b32 s69, s69, 12
    s_lshl_b32 s70, s70, 12
    s_add_u32 s64, s64, s61
    s_add_u32 s65, s65, s61
    s_add_u32 s66, s66, s61
    s_add_u32 s67, s67, s61
    s_add_u32 s68, s68, s61
    s_add_u32 s69, s69, s61
    s_add_u32 s70, s70, s61
    v_mov_b32 v17, 0
    v_and_b32 v6, 7, v0
    v_lshlrev_b32 v6, 4, v6
    s_lshl_b32 s43, s7, 7
    buffer_load_dwordx4 v[2:5], v6, s[36:39], s43 offen
    s_barrier
    v_xor_b32 v19, 96, v8
    ds_read_b64_tr_b16 v[96:97], v8 offset:0
    ds_read_b64_tr_b16 v[98:99], v8 offset:2048
    ds_read_b64_tr_b16 v[100:101], v9 offset:0
    ds_read_b64_tr_b16 v[102:103], v9 offset:2048
    ds_read_b64_tr_b16 v[104:105], v10 offset:0
    ds_read_b64_tr_b16 v[106:107], v10 offset:2048
    ds_read_b64_tr_b16 v[108:109], v19 offset:0
    ds_read_b64_tr_b16 v[110:111], v19 offset:2048
    ds_read_b64_tr_b16 v[112:113], v8 offset:8192
    ds_read_b64_tr_b16 v[114:115], v8 offset:10240
    ds_read_b64_tr_b16 v[116:117], v9 offset:8192
    ds_read_b64_tr_b16 v[118:119], v9 offset:10240
    ds_read_b64_tr_b16 v[120:121], v10 offset:8192
    ds_read_b64_tr_b16 v[122:123], v10 offset:10240
    ds_read_b64_tr_b16 v[124:125], v19 offset:8192
    ds_read_b64_tr_b16 v[126:127], v19 offset:10240
    v_add_u32 v8, 0xfffe0000, v8
    v_add_u32 v9, 0xfffe0000, v9
    v_add_u32 v10, 0xfffe0000, v10
    v_add_u32 v19, 0xfffe0000, v19
    ds_read_b64_tr_b16 v[128:129], v8 offset:0
    ds_read_b64_tr_b16 v[130:131], v8 offset:2048
    ds_read_b64_tr_b16 v[132:133], v9 offset:0
    ds_read_b64_tr_b16 v[134:135], v9 offset:2048
    ds_read_b64_tr_b16 v[136:137], v10 offset:0
    ds_read_b64_tr_b16 v[138:139], v10 offset:2048
    ds_read_b64_tr_b16 v[140:141], v19 offset:0
    ds_read_b64_tr_b16 v[142:143], v19 offset:2048
    ds_read_b64_tr_b16 v[144:145], v8 offset:8192
    ds_read_b64_tr_b16 v[146:147], v8 offset:10240
    ds_read_b64_tr_b16 v[148:149], v9 offset:8192
    ds_read_b64_tr_b16 v[150:151], v9 offset:10240
    ds_read_b64_tr_b16 v[152:153], v10 offset:8192
    ds_read_b64_tr_b16 v[154:155], v10 offset:10240
    ds_read_b64_tr_b16 v[156:157], v19 offset:8192
    ds_read_b64_tr_b16 v[158:159], v19 offset:10240
    s_waitcnt vmcnt(0) lgkmcnt(0)
    s_barrier
    ds_read_b64_tr_b16 v[160:161], v8 offset:16384
    ds_read_b64_tr_b16 v[162:163], v8 offset:18432
    ds_read_b64_tr_b16 v[164:165], v9 offset:16384
    ds_read_b64_tr_b16 v[166:167], v9 offset:18432
    ds_read_b64_tr_b16 v[168:169], v10 offset:16384
    ds_read_b64_tr_b16 v[170:171], v10 offset:18432
    ds_read_b64_tr_b16 v[172:173], v19 offset:16384
    ds_read_b64_tr_b16 v[174:175], v19 offset:18432
    ds_read_b64_tr_b16 v[176:177], v8 offset:24576
    ds_read_b64_tr_b16 v[178:179], v8 offset:26624
    ds_read_b64_tr_b16 v[180:181], v9 offset:24576
    ds_read_b64_tr_b16 v[182:183], v9 offset:26624
    ds_read_b64_tr_b16 v[184:185], v10 offset:24576
    ds_read_b64_tr_b16 v[186:187], v10 offset:26624
    ds_read_b64_tr_b16 v[188:189], v19 offset:24576
    ds_read_b64_tr_b16 v[190:191], v19 offset:26624
    ds_read_b64_tr_b16 v[192:193], v8 offset:32768
    ds_read_b64_tr_b16 v[194:195], v8 offset:34816
    ds_read_b64_tr_b16 v[196:197], v9 offset:32768
    ds_read_b64_tr_b16 v[198:199], v9 offset:34816
    ds_read_b64_tr_b16 v[200:201], v10 offset:32768
    ds_read_b64_tr_b16 v[202:203], v10 offset:34816
    ds_read_b64_tr_b16 v[204:205], v19 offset:32768
    ds_read_b64_tr_b16 v[206:207], v19 offset:34816
    ds_read_b64_tr_b16 v[208:209], v8 offset:40960
    ds_read_b64_tr_b16 v[210:211], v8 offset:43008
    ds_read_b64_tr_b16 v[212:213], v9 offset:40960
    ds_read_b64_tr_b16 v[214:215], v9 offset:43008
    ds_read_b64_tr_b16 v[216:217], v10 offset:40960
    ds_read_b64_tr_b16 v[218:219], v10 offset:43008
    ds_read_b64_tr_b16 v[220:221], v19 offset:40960
    ds_read_b64_tr_b16 v[222:223], v19 offset:43008
    v_lshlrev_b32 v20, 16, v2
    v_and_b32 v21, s55, v2
    v_lshlrev_b32 v22, 16, v3
    v_and_b32 v23, s55, v3
    v_lshlrev_b32 v24, 16, v4
    v_and_b32 v25, s55, v4
    v_lshlrev_b32 v26, 16, v5
    v_and_b32 v27, s55, v5
    v_lshrrev_b32 v29, 3, v0
    s_lshl_b32 s43, s3, 3
    v_add_u32 v29, s43, v29
    v_lshl_add_u32 v30, v29, 10, v6
    v_and_b32 v28, 7, v0
    v_lshlrev_b32 v28, 1, v28
    v_and_b32 v2, 15, v29
    v_xor_b32 v28, v28, v2
    v_lshlrev_b32 v28, 4, v28
    v_lshl_add_u32 v28, v29, 8, v28
    v_add_u32 v28, 49152, v28
    v_xor_b32 v29, 16, v28
    s_lshl_b32 s47, s4, 17
    s_lshl_b32 s44, s6, 16
    s_add_u32 s47, s47, s44
    s_lshl_b32 s44, s7, 7
    s_add_u32 s47, s47, s44
    s_branch L_c_p2
L_c_reg:
    s_barrier
    ds_read_b64_tr_b16 v[128:129], v4 offset:0
    ds_read_b64_tr_b16 v[130:131], v4 offset:1024
    ds_read_b128 v[96:99], v2 offset:0
    ds_read_b128 v[100:103], v2 offset:2048
    ds_read_b128 v[104:107], v2 offset:4096
    ds_read_b128 v[108:111], v2 offset:6144
    ds_read_b64_tr_b16 v[136:137], v5 offset:0
    ds_read_b64_tr_b16 v[138:139], v5 offset:1024
    ds_read_b64_tr_b16 v[144:145], v6 offset:0
    ds_read_b64_tr_b16 v[146:147], v6 offset:1024
    ds_read_b64_tr_b16 v[152:153], v7 offset:0
    ds_read_b64_tr_b16 v[154:155], v7 offset:1024
    ds_read_b64_tr_b16 v[132:133], v4 offset:8192
    ds_read_b64_tr_b16 v[134:135], v4 offset:9216
    ds_read_b128 v[112:115], v3 offset:0
    ds_read_b128 v[116:119], v3 offset:2048
    ds_read_b128 v[120:123], v3 offset:4096
    ds_read_b128 v[124:127], v3 offset:6144
    ds_read_b64_tr_b16 v[140:141], v5 offset:8192
    ds_read_b64_tr_b16 v[142:143], v5 offset:9216
    ds_read_b64_tr_b16 v[148:149], v6 offset:8192
    ds_read_b64_tr_b16 v[150:151], v6 offset:9216
    ds_read_b64_tr_b16 v[156:157], v7 offset:8192
    ds_read_b64_tr_b16 v[158:159], v7 offset:9216
    s_waitcnt lgkmcnt(14)
    v_mfma_f32_16x16x32_bf16 v[32:35], v[128:131], v[96:99], 0
    s_mov_b32 s36, 0x7654f210
    s_mov_b32 s37, 0x3bdcea98
    s_lshl_b32 s7, s5, 2
    v_mfma_f32_16x16x32_bf16 v[48:51], v[128:131], v[100:103], 0
    s_lshr_b64 s[36:37], s[36:37], s7
    s_bfe_u32 s6, s36, 0x10003
    s_and_b32 s7, s36, 7
    v_mfma_f32_16x16x32_bf16 v[64:67], v[128:131], v[104:107], 0
    s_mov_b32 s55, 0xffff0000
    s_mov_b64 s[36:37], s[72:73]
    s_mov_b32 s38, 1024
    v_mfma_f32_16x16x32_bf16 v[80:83], v[128:131], v[108:111], 0
    s_mov_b32 s39, 0x20000
    s_mov_b64 s[24:25], s[74:75]
    s_mov_b32 s26, 2097152
    v_mfma_f32_16x16x32_bf16 v[36:39], v[136:139], v[96:99], 0
    s_mov_b32 s27, 0x20000
    s_add_u32 s20, s78, 0
    s_addc_u32 s21, s79, 0
    v_mfma_f32_16x16x32_bf16 v[52:55], v[136:139], v[100:103], 0
    s_mov_b32 s22, 16777216
    s_mov_b32 s23, 0x20000
    s_getreg_b32 s41, hwreg(HW_REG_XCC_ID, 0, 3)
    v_mfma_f32_16x16x32_bf16 v[68:71], v[136:139], v[104:107], 0
    s_lshl_b32 s50, s4, 19
    s_add_u32 s50, s50, 458752
    v_lshlrev_b32 v11, 4, v0
    v_mfma_f32_16x16x32_bf16 v[84:87], v[136:139], v[108:111], 0
    v_lshl_add_u32 v238, v233, 2, v234
    v_lshrrev_b32 v237, 1, v238
    v_and_b32 v237, 3, v237
    v_mfma_f32_16x16x32_bf16 v[40:43], v[144:147], v[96:99], 0
    v_lshlrev_b32 v238, 7, v238
    v_lshl_add_u32 v238, v235, 3, v238
    v_lshl_add_u32 v238, v237, 5, v238
    v_mfma_f32_16x16x32_bf16 v[56:59], v[144:147], v[100:103], 0
    s_lshl_b32 s43, s59, 12
    s_add_u32 s43, s43, 131072
    v_add_u32 v8, s43, v238
    v_mfma_f32_16x16x32_bf16 v[72:75], v[144:147], v[104:107], 0
    v_xor_b32 v9, 32, v8
    v_xor_b32 v10, 64, v8
    s_lshl_b32 s51, s4, 19
    v_mfma_f32_16x16x32_bf16 v[88:91], v[144:147], v[108:111], 0
    s_mul_i32 s43, s59, 57344
    s_add_u32 s51, s51, s43
    s_mul_i32 s43, s6, 229376
    s_waitcnt lgkmcnt(12)
    v_mfma_f32_16x16x32_bf16 v[44:47], v[152:155], v[96:99], 0
    s_add_u32 s61, s51, s43
    s_mul_i32 s43, s58, 114688
    s_add_u32 s61, s61, s43
    v_mfma_f32_16x16x32_bf16 v[60:63], v[152:155], v[100:103], 0
    v_lshlrev_b32 v16, 8, v232
    v_xor_b32 v237, v233, v232
    v_lshl_add_u32 v16, v237, 4, v16
    v_mfma_f32_16x16x32_bf16 v[76:79], v[152:155], v[104:107], 0
    s_lshl_b32 s43, s59, 14
    s_lshl_b32 s44, s58, 13
    s_add_u32 s43, s43, s44
    v_mfma_f32_16x16x32_bf16 v[92:95], v[152:155], v[108:111], 0
    s_add_u32 s43, s43, 49152
    v_add_u32 v16, s43, v16
    s_mov_b64 s[32:33], s[68:69]
    s_waitcnt lgkmcnt(9)
    v_mfma_f32_16x16x32_bf16 v[32:35], v[132:135], v[112:115], v[32:35]
    s_mov_b32 s34, 3584
    s_mov_b32 s35, 0x20000
    v_lshlrev_b32 v239, 1, v232
    s_waitcnt lgkmcnt(8)
    v_mfma_f32_16x16x32_bf16 v[48:51], v[132:135], v[116:119], v[48:51]
    s_lshl_b32 s43, s5, 8
    s_lshl_b32 s44, s59, 7
    s_add_u32 s43, s43, s44
    s_waitcnt lgkmcnt(7)
    v_mfma_f32_16x16x32_bf16 v[64:67], v[132:135], v[120:123], v[64:67]
    s_lshl_b32 s44, s58, 6
    s_add_u32 s43, s43, s44
    buffer_load_ushort v229, v239, s[32:35], s43 offen offset:0
    s_waitcnt lgkmcnt(6)
    v_mfma_f32_16x16x32_bf16 v[80:83], v[132:135], v[124:127], v[80:83]
    buffer_load_ushort v230, v239, s[32:35], s43 offen offset:32
    s_mul_i32 s43, s58, 229376
    s_add_u32 s51, s51, s43
    s_waitcnt lgkmcnt(4)
    v_mfma_f32_16x16x32_bf16 v[36:39], v[140:143], v[112:115], v[36:39]
    s_waitcnt lgkmcnt(0)
    s_barrier
    ds_read_b64_tr_b16 v[192:193], v4 offset:32768
    ds_read_b64_tr_b16 v[194:195], v4 offset:33792
    v_smfmac_f32_16x16x64_bf16 v[240:243], v[12:15], v[128:135], v18
    ds_read_b128 v[160:163], v2 offset:32768
    ds_read_b128 v[164:167], v2 offset:34816
    v_mfma_f32_16x16x32_bf16 v[52:55], v[140:143], v[116:119], v[52:55]
    ds_read_b128 v[168:171], v2 offset:36864
    ds_read_b128 v[172:175], v2 offset:38912
    v_smfmac_f32_16x16x64_bf16 v[244:247], v[12:15], v[136:143], v18
    ds_read_b64_tr_b16 v[200:201], v5 offset:32768
    ds_read_b64_tr_b16 v[202:203], v5 offset:33792
    v_mfma_f32_16x16x32_bf16 v[68:71], v[140:143], v[120:123], v[68:71]
    ds_read_b64_tr_b16 v[208:209], v6 offset:32768
    ds_read_b64_tr_b16 v[210:211], v6 offset:33792
    v_mfma_f32_16x16x32_bf16 v[84:87], v[140:143], v[124:127], v[84:87]
    ds_read_b64_tr_b16 v[216:217], v7 offset:32768
    ds_read_b64_tr_b16 v[218:219], v7 offset:33792
    v_mfma_f32_16x16x32_bf16 v[40:43], v[148:151], v[112:115], v[40:43]
    ds_read_b64_tr_b16 v[196:197], v4 offset:40960
    ds_read_b64_tr_b16 v[198:199], v4 offset:41984
    v_mfma_f32_16x16x32_bf16 v[56:59], v[148:151], v[116:119], v[56:59]
    ds_read_b128 v[176:179], v3 offset:32768
    ds_read_b128 v[180:183], v3 offset:34816
    v_mfma_f32_16x16x32_bf16 v[72:75], v[148:151], v[120:123], v[72:75]
    ds_read_b128 v[184:187], v3 offset:36864
    ds_read_b128 v[188:191], v3 offset:38912
    v_mfma_f32_16x16x32_bf16 v[88:91], v[148:151], v[124:127], v[88:91]
    ds_read_b64_tr_b16 v[204:205], v5 offset:40960
    ds_read_b64_tr_b16 v[206:207], v5 offset:41984
    v_mfma_f32_16x16x32_bf16 v[44:47], v[156:159], v[112:115], v[44:47]
    ds_read_b64_tr_b16 v[212:213], v6 offset:40960
    ds_read_b64_tr_b16 v[214:215], v6 offset:41984
    v_mfma_f32_16x16x32_bf16 v[60:63], v[156:159], v[116:119], v[60:63]
    ds_read_b64_tr_b16 v[220:221], v7 offset:40960
    ds_read_b64_tr_b16 v[222:223], v7 offset:41984
    v_mfma_f32_16x16x32_bf16 v[76:79], v[156:159], v[120:123], v[76:79]
    s_lshl_b32 s43, s5, 11
    s_add_u32 s51, s51, s43
    s_lshl_b32 s43, s3, 7
    v_mfma_f32_16x16x32_bf16 v[92:95], v[156:159], v[124:127], v[92:95]
    s_lshl_b32 s44, s5, 2
    s_add_u32 s43, s43, s44
    v_mov_b32 v17, s43
    s_waitcnt lgkmcnt(14)
    v_mfma_f32_16x16x32_bf16 v[32:35], v[192:195], v[160:163], v[32:35]
    v_xor_b32 v2, 0x10000, v2
    v_mfma_f32_16x16x32_bf16 v[48:51], v[192:195], v[164:167], v[48:51]
    s_mov_b32 s40, 0x01000100
    s_mov_b32 s12, 0x07060302
    s_mov_b32 s13, 0x05040302
    v_mfma_f32_16x16x32_bf16 v[64:67], v[192:195], v[168:171], v[64:67]
    v_xor_b32 v3, 0x10000, v3
    v_mfma_f32_16x16x32_bf16 v[80:83], v[192:195], v[172:175], v[80:83]
    s_mov_b64 s[100:101], 0xffff
    v_lshlrev_b32 v19, 3, v232
    s_lshl_b32 s43, s58, 9
    v_mfma_f32_16x16x32_bf16 v[36:39], v[200:203], v[160:163], v[36:39]
    v_xor_b32 v4, 0x10000, v4
    v_mfma_f32_16x16x32_bf16 v[52:55], v[200:203], v[164:167], v[52:55]
    s_add_u32 s43, s43, 147456
    v_add_u32 v19, s43, v19
    v_lshlrev_b32 v1, 6, v232
    v_mfma_f32_16x16x32_bf16 v[68:71], v[200:203], v[168:171], v[68:71]
    v_xor_b32 v5, 0x10000, v5
    v_mfma_f32_16x16x32_bf16 v[84:87], v[200:203], v[172:175], v[84:87]
    v_add_u32 v1, 147460, v1
    s_lshl_b32 s43, s3, 10
    s_add_u32 s43, s43, 151552
    v_mfma_f32_16x16x32_bf16 v[40:43], v[208:211], v[160:163], v[40:43]
    v_xor_b32 v6, 0x10000, v6
    v_mfma_f32_16x16x32_bf16 v[56:59], v[208:211], v[164:167], v[56:59]
    v_add_u32 v231, s43, v11
    s_mov_b32 s64, 0
    s_add_u32 s65, s64, 1
    v_mfma_f32_16x16x32_bf16 v[72:75], v[208:211], v[168:171], v[72:75]
    v_xor_b32 v7, 0x10000, v7
    v_mfma_f32_16x16x32_bf16 v[88:91], v[208:211], v[172:175], v[88:91]
    s_cmp_eq_u32 s65, 7
    s_cselect_b32 s65, 0, s65
    s_add_u32 s66, s65, 1
    s_waitcnt lgkmcnt(12)
    v_mfma_f32_16x16x32_bf16 v[44:47], v[216:219], v[160:163], v[44:47]
    s_waitcnt lgkmcnt(0)
    s_barrier
    ds_read_b64_tr_b16 v[128:129], v4 offset:0
    ds_read_b64_tr_b16 v[130:131], v4 offset:1024
    v_smfmac_f32_16x16x64_bf16 v[240:243], v[12:15], v[192:199], v18
    ds_read_b128 v[96:99], v2 offset:0
    ds_read_b128 v[100:103], v2 offset:2048
    v_mfma_f32_16x16x32_bf16 v[60:63], v[216:219], v[164:167], v[60:63]
    ds_read_b128 v[104:107], v2 offset:4096
    ds_read_b128 v[108:111], v2 offset:6144
    v_smfmac_f32_16x16x64_bf16 v[244:247], v[12:15], v[200:207], v18
    ds_read_b64_tr_b16 v[136:137], v5 offset:0
    ds_read_b64_tr_b16 v[138:139], v5 offset:1024
    v_mfma_f32_16x16x32_bf16 v[76:79], v[216:219], v[168:171], v[76:79]
    ds_read_b64_tr_b16 v[144:145], v6 offset:0
    ds_read_b64_tr_b16 v[146:147], v6 offset:1024
    v_mfma_f32_16x16x32_bf16 v[92:95], v[216:219], v[172:175], v[92:95]
    ds_read_b64_tr_b16 v[152:153], v7 offset:0
    ds_read_b64_tr_b16 v[154:155], v7 offset:1024
    v_mfma_f32_16x16x32_bf16 v[32:35], v[196:199], v[176:179], v[32:35]
    ds_read_b64_tr_b16 v[132:133], v4 offset:8192
    ds_read_b64_tr_b16 v[134:135], v4 offset:9216
    v_mfma_f32_16x16x32_bf16 v[48:51], v[196:199], v[180:183], v[48:51]
    ds_read_b128 v[112:115], v3 offset:0
    ds_read_b128 v[116:119], v3 offset:2048
    v_mfma_f32_16x16x32_bf16 v[64:67], v[196:199], v[184:187], v[64:67]
    ds_read_b128 v[120:123], v3 offset:4096
    ds_read_b128 v[124:127], v3 offset:6144
    v_mfma_f32_16x16x32_bf16 v[80:83], v[196:199], v[188:191], v[80:83]
    ds_read_b64_tr_b16 v[140:141], v5 offset:8192
    ds_read_b64_tr_b16 v[142:143], v5 offset:9216
    v_mfma_f32_16x16x32_bf16 v[36:39], v[204:207], v[176:179], v[36:39]
    ds_read_b64_tr_b16 v[148:149], v6 offset:8192
    ds_read_b64_tr_b16 v[150:151], v6 offset:9216
    v_mfma_f32_16x16x32_bf16 v[52:55], v[204:207], v[180:183], v[52:55]
    ds_read_b64_tr_b16 v[156:157], v7 offset:8192
    ds_read_b64_tr_b16 v[158:159], v7 offset:9216
    v_mfma_f32_16x16x32_bf16 v[68:71], v[204:207], v[184:187], v[68:71]
    s_cmp_eq_u32 s66, 7
    s_cselect_b32 s66, 0, s66
    s_add_u32 s67, s66, 1
    v_mfma_f32_16x16x32_bf16 v[84:87], v[204:207], v[188:191], v[84:87]
    s_cmp_eq_u32 s67, 7
    s_cselect_b32 s67, 0, s67
    s_add_u32 s68, s67, 1
    v_mfma_f32_16x16x32_bf16 v[40:43], v[212:215], v[176:179], v[40:43]
    s_cmp_eq_u32 s68, 7
    s_cselect_b32 s68, 0, s68
    s_add_u32 s69, s68, 1
    v_mfma_f32_16x16x32_bf16 v[56:59], v[212:215], v[180:183], v[56:59]
    s_cmp_eq_u32 s69, 7
    s_cselect_b32 s69, 0, s69
    s_add_u32 s70, s69, 1
    v_mfma_f32_16x16x32_bf16 v[72:75], v[212:215], v[184:187], v[72:75]
    s_cmp_eq_u32 s70, 7
    s_cselect_b32 s70, 0, s70
    s_lshl_b32 s64, s64, 12
    v_mfma_f32_16x16x32_bf16 v[88:91], v[212:215], v[188:191], v[88:91]
    s_lshl_b32 s65, s65, 12
    s_lshl_b32 s66, s66, 12
    s_lshl_b32 s67, s67, 12
    v_mfma_f32_16x16x32_bf16 v[44:47], v[220:223], v[176:179], v[44:47]
    s_lshl_b32 s68, s68, 12
    s_lshl_b32 s69, s69, 12
    s_lshl_b32 s70, s70, 12
    v_mfma_f32_16x16x32_bf16 v[60:63], v[220:223], v[180:183], v[60:63]
    s_add_u32 s64, s64, s61
    s_add_u32 s65, s65, s61
    s_add_u32 s66, s66, s61
    v_mfma_f32_16x16x32_bf16 v[76:79], v[220:223], v[184:187], v[76:79]
    s_add_u32 s67, s67, s61
    s_add_u32 s68, s68, s61
    s_add_u32 s69, s69, s61
    v_mfma_f32_16x16x32_bf16 v[92:95], v[220:223], v[188:191], v[92:95]
    s_add_u32 s70, s70, s61
    s_waitcnt lgkmcnt(14)
    v_mfma_f32_16x16x32_bf16 v[32:35], v[128:131], v[96:99], v[32:35]
    v_mfma_f32_16x16x32_bf16 v[48:51], v[128:131], v[100:103], v[48:51]
    v_mfma_f32_16x16x32_bf16 v[64:67], v[128:131], v[104:107], v[64:67]
    v_mfma_f32_16x16x32_bf16 v[80:83], v[128:131], v[108:111], v[80:83]
    v_mfma_f32_16x16x32_bf16 v[36:39], v[136:139], v[96:99], v[36:39]
    v_mfma_f32_16x16x32_bf16 v[52:55], v[136:139], v[100:103], v[52:55]
    v_mfma_f32_16x16x32_bf16 v[68:71], v[136:139], v[104:107], v[68:71]
    s_waitcnt lgkmcnt(0)
    s_barrier
    ds_read_b64_tr_b16 v[192:193], v4 offset:32768
    v_smfmac_f32_16x16x64_bf16 v[240:243], v[12:15], v[128:135], v18
    ds_read_b64_tr_b16 v[194:195], v4 offset:33792
    v_mfma_f32_16x16x32_bf16 v[84:87], v[136:139], v[108:111], v[84:87]
    ds_read_b128 v[160:163], v2 offset:32768
    v_smfmac_f32_16x16x64_bf16 v[244:247], v[12:15], v[136:143], v18
    ds_read_b128 v[164:167], v2 offset:34816
    v_mfma_f32_16x16x32_bf16 v[40:43], v[144:147], v[96:99], v[40:43]
    ds_read_b128 v[168:171], v2 offset:36864
    v_mfma_f32_16x16x32_bf16 v[56:59], v[144:147], v[100:103], v[56:59]
    ds_read_b128 v[172:175], v2 offset:38912
    v_mfma_f32_16x16x32_bf16 v[72:75], v[144:147], v[104:107], v[72:75]
    ds_read_b64_tr_b16 v[200:201], v5 offset:32768
    v_mfma_f32_16x16x32_bf16 v[88:91], v[144:147], v[108:111], v[88:91]
    ds_read_b64_tr_b16 v[202:203], v5 offset:33792
    v_mfma_f32_16x16x32_bf16 v[44:47], v[152:155], v[96:99], v[44:47]
    ds_read_b64_tr_b16 v[208:209], v6 offset:32768
    v_mfma_f32_16x16x32_bf16 v[60:63], v[152:155], v[100:103], v[60:63]
    ds_read_b64_tr_b16 v[210:211], v6 offset:33792
    v_mfma_f32_16x16x32_bf16 v[76:79], v[152:155], v[104:107], v[76:79]
    ds_read_b64_tr_b16 v[216:217], v7 offset:32768
    v_mfma_f32_16x16x32_bf16 v[92:95], v[152:155], v[108:111], v[92:95]
    ds_read_b64_tr_b16 v[218:219], v7 offset:33792
    v_mfma_f32_16x16x32_bf16 v[32:35], v[132:135], v[112:115], v[32:35]
    ds_read_b64_tr_b16 v[196:197], v4 offset:40960
    v_mfma_f32_16x16x32_bf16 v[48:51], v[132:135], v[116:119], v[48:51]
    ds_read_b64_tr_b16 v[198:199], v4 offset:41984
    v_mfma_f32_16x16x32_bf16 v[64:67], v[132:135], v[120:123], v[64:67]
    ds_read_b128 v[176:179], v3 offset:32768
    v_mfma_f32_16x16x32_bf16 v[80:83], v[132:135], v[124:127], v[80:83]
    ds_read_b128 v[180:183], v3 offset:34816
    v_mfma_f32_16x16x32_bf16 v[36:39], v[140:143], v[112:115], v[36:39]
    ds_read_b128 v[184:187], v3 offset:36864
    v_mfma_f32_16x16x32_bf16 v[52:55], v[140:143], v[116:119], v[52:55]
    ds_read_b128 v[188:191], v3 offset:38912
    v_mfma_f32_16x16x32_bf16 v[68:71], v[140:143], v[120:123], v[68:71]
    ds_read_b64_tr_b16 v[204:205], v5 offset:40960
    v_mfma_f32_16x16x32_bf16 v[84:87], v[140:143], v[124:127], v[84:87]
    ds_read_b64_tr_b16 v[206:207], v5 offset:41984
    v_mfma_f32_16x16x32_bf16 v[40:43], v[148:151], v[112:115], v[40:43]
    ds_read_b64_tr_b16 v[212:213], v6 offset:40960
    v_mfma_f32_16x16x32_bf16 v[56:59], v[148:151], v[116:119], v[56:59]
    ds_read_b64_tr_b16 v[214:215], v6 offset:41984
    v_mfma_f32_16x16x32_bf16 v[72:75], v[148:151], v[120:123], v[72:75]
    ds_read_b64_tr_b16 v[220:221], v7 offset:40960
    v_mfma_f32_16x16x32_bf16 v[88:91], v[148:151], v[124:127], v[88:91]
    ds_read_b64_tr_b16 v[222:223], v7 offset:41984
    v_mfma_f32_16x16x32_bf16 v[44:47], v[156:159], v[112:115], v[44:47]
    v_mfma_f32_16x16x32_bf16 v[60:63], v[156:159], v[116:119], v[60:63]
    v_mfma_f32_16x16x32_bf16 v[76:79], v[156:159], v[120:123], v[76:79]
    v_mfma_f32_16x16x32_bf16 v[92:95], v[156:159], v[124:127], v[92:95]
    s_waitcnt lgkmcnt(14)
    v_mfma_f32_16x16x32_bf16 v[32:35], v[192:195], v[160:163], v[32:35]
    v_xor_b32 v2, 0x10000, v2
    v_mfma_f32_16x16x32_bf16 v[48:51], v[192:195], v[164:167], v[48:51]
    v_xor_b32 v3, 0x10000, v3
    v_mfma_f32_16x16x32_bf16 v[64:67], v[192:195], v[168:171], v[64:67]
    v_xor_b32 v4, 0x10000, v4
    v_mfma_f32_16x16x32_bf16 v[80:83], v[192:195], v[172:175], v[80:83]
    v_xor_b32 v5, 0x10000, v5
    v_mfma_f32_16x16x32_bf16 v[36:39], v[200:203], v[160:163], v[36:39]
    v_xor_b32 v6, 0x10000, v6
    v_mfma_f32_16x16x32_bf16 v[52:55], v[200:203], v[164:167], v[52:55]
    v_xor_b32 v7, 0x10000, v7
    v_mfma_f32_16x16x32_bf16 v[68:71], v[200:203], v[168:171], v[68:71]
    s_waitcnt lgkmcnt(0)
    s_barrier
    ds_read_b64_tr_b16 v[128:129], v4 offset:0
    v_smfmac_f32_16x16x64_bf16 v[240:243], v[12:15], v[192:199], v18
    ds_read_b64_tr_b16 v[130:131], v4 offset:1024
    v_mfma_f32_16x16x32_bf16 v[84:87], v[200:203], v[172:175], v[84:87]
    ds_read_b128 v[96:99], v2 offset:0
    v_smfmac_f32_16x16x64_bf16 v[244:247], v[12:15], v[200:207], v18
    ds_read_b128 v[100:103], v2 offset:2048
    v_mfma_f32_16x16x32_bf16 v[40:43], v[208:211], v[160:163], v[40:43]
    ds_read_b128 v[104:107], v2 offset:4096
    v_mfma_f32_16x16x32_bf16 v[56:59], v[208:211], v[164:167], v[56:59]
    ds_read_b128 v[108:111], v2 offset:6144
    v_mfma_f32_16x16x32_bf16 v[72:75], v[208:211], v[168:171], v[72:75]
    ds_read_b64_tr_b16 v[136:137], v5 offset:0
    v_mfma_f32_16x16x32_bf16 v[88:91], v[208:211], v[172:175], v[88:91]
    ds_read_b64_tr_b16 v[138:139], v5 offset:1024
    v_mfma_f32_16x16x32_bf16 v[44:47], v[216:219], v[160:163], v[44:47]
    ds_read_b64_tr_b16 v[144:145], v6 offset:0
    v_mfma_f32_16x16x32_bf16 v[60:63], v[216:219], v[164:167], v[60:63]
    ds_read_b64_tr_b16 v[146:147], v6 offset:1024
    v_mfma_f32_16x16x32_bf16 v[76:79], v[216:219], v[168:171], v[76:79]
    ds_read_b64_tr_b16 v[152:153], v7 offset:0
    v_mfma_f32_16x16x32_bf16 v[92:95], v[216:219], v[172:175], v[92:95]
    ds_read_b64_tr_b16 v[154:155], v7 offset:1024
    v_mfma_f32_16x16x32_bf16 v[32:35], v[196:199], v[176:179], v[32:35]
    ds_read_b64_tr_b16 v[132:133], v4 offset:8192
    v_mfma_f32_16x16x32_bf16 v[48:51], v[196:199], v[180:183], v[48:51]
    ds_read_b64_tr_b16 v[134:135], v4 offset:9216
    v_mfma_f32_16x16x32_bf16 v[64:67], v[196:199], v[184:187], v[64:67]
    ds_read_b128 v[112:115], v3 offset:0
    v_mfma_f32_16x16x32_bf16 v[80:83], v[196:199], v[188:191], v[80:83]
    ds_read_b128 v[116:119], v3 offset:2048
    v_mfma_f32_16x16x32_bf16 v[36:39], v[204:207], v[176:179], v[36:39]
    ds_read_b128 v[120:123], v3 offset:4096
    v_mfma_f32_16x16x32_bf16 v[52:55], v[204:207], v[180:183], v[52:55]
    ds_read_b128 v[124:127], v3 offset:6144
    v_mfma_f32_16x16x32_bf16 v[68:71], v[204:207], v[184:187], v[68:71]
    ds_read_b64_tr_b16 v[140:141], v5 offset:8192
    v_mfma_f32_16x16x32_bf16 v[84:87], v[204:207], v[188:191], v[84:87]
    ds_read_b64_tr_b16 v[142:143], v5 offset:9216
    v_mfma_f32_16x16x32_bf16 v[40:43], v[212:215], v[176:179], v[40:43]
    ds_read_b64_tr_b16 v[148:149], v6 offset:8192
    v_mfma_f32_16x16x32_bf16 v[56:59], v[212:215], v[180:183], v[56:59]
    ds_read_b64_tr_b16 v[150:151], v6 offset:9216
    v_mfma_f32_16x16x32_bf16 v[72:75], v[212:215], v[184:187], v[72:75]
    ds_read_b64_tr_b16 v[156:157], v7 offset:8192
    v_mfma_f32_16x16x32_bf16 v[88:91], v[212:215], v[188:191], v[88:91]
    ds_read_b64_tr_b16 v[158:159], v7 offset:9216
    v_mfma_f32_16x16x32_bf16 v[44:47], v[220:223], v[176:179], v[44:47]
    v_mfma_f32_16x16x32_bf16 v[60:63], v[220:223], v[180:183], v[60:63]
    v_mfma_f32_16x16x32_bf16 v[76:79], v[220:223], v[184:187], v[76:79]
    v_mfma_f32_16x16x32_bf16 v[92:95], v[220:223], v[188:191], v[92:95]
    s_waitcnt lgkmcnt(14)
    v_mfma_f32_16x16x32_bf16 v[32:35], v[128:131], v[96:99], v[32:35]
    v_mfma_f32_16x16x32_bf16 v[48:51], v[128:131], v[100:103], v[48:51]
    v_mfma_f32_16x16x32_bf16 v[64:67], v[128:131], v[104:107], v[64:67]
    v_mfma_f32_16x16x32_bf16 v[80:83], v[128:131], v[108:111], v[80:83]
    v_mfma_f32_16x16x32_bf16 v[36:39], v[136:139], v[96:99], v[36:39]
    v_mfma_f32_16x16x32_bf16 v[52:55], v[136:139], v[100:103], v[52:55]
    v_mfma_f32_16x16x32_bf16 v[68:71], v[136:139], v[104:107], v[68:71]
    s_waitcnt lgkmcnt(0)
    s_barrier
    ds_read_b64_tr_b16 v[192:193], v4 offset:32768
    v_smfmac_f32_16x16x64_bf16 v[240:243], v[12:15], v[128:135], v18
    ds_read_b64_tr_b16 v[194:195], v4 offset:33792
    v_mfma_f32_16x16x32_bf16 v[84:87], v[136:139], v[108:111], v[84:87]
    ds_read_b128 v[160:163], v2 offset:32768
    v_smfmac_f32_16x16x64_bf16 v[244:247], v[12:15], v[136:143], v18
    ds_read_b128 v[164:167], v2 offset:34816
    v_mfma_f32_16x16x32_bf16 v[40:43], v[144:147], v[96:99], v[40:43]
    ds_read_b128 v[168:171], v2 offset:36864
    v_mfma_f32_16x16x32_bf16 v[56:59], v[144:147], v[100:103], v[56:59]
    ds_read_b128 v[172:175], v2 offset:38912
    v_mfma_f32_16x16x32_bf16 v[72:75], v[144:147], v[104:107], v[72:75]
    ds_read_b64_tr_b16 v[200:201], v5 offset:32768
    v_mfma_f32_16x16x32_bf16 v[88:91], v[144:147], v[108:111], v[88:91]
    ds_read_b64_tr_b16 v[202:203], v5 offset:33792
    v_mfma_f32_16x16x32_bf16 v[44:47], v[152:155], v[96:99], v[44:47]
    ds_read_b64_tr_b16 v[208:209], v6 offset:32768
    v_mfma_f32_16x16x32_bf16 v[60:63], v[152:155], v[100:103], v[60:63]
    ds_read_b64_tr_b16 v[210:211], v6 offset:33792
    v_mfma_f32_16x16x32_bf16 v[76:79], v[152:155], v[104:107], v[76:79]
    ds_read_b64_tr_b16 v[216:217], v7 offset:32768
    v_mfma_f32_16x16x32_bf16 v[92:95], v[152:155], v[108:111], v[92:95]
    ds_read_b64_tr_b16 v[218:219], v7 offset:33792
    v_mfma_f32_16x16x32_bf16 v[32:35], v[132:135], v[112:115], v[32:35]
    ds_read_b64_tr_b16 v[196:197], v4 offset:40960
    v_mfma_f32_16x16x32_bf16 v[48:51], v[132:135], v[116:119], v[48:51]
    ds_read_b64_tr_b16 v[198:199], v4 offset:41984
    v_mfma_f32_16x16x32_bf16 v[64:67], v[132:135], v[120:123], v[64:67]
    ds_read_b128 v[176:179], v3 offset:32768
    v_mfma_f32_16x16x32_bf16 v[80:83], v[132:135], v[124:127], v[80:83]
    ds_read_b128 v[180:183], v3 offset:34816
    v_mfma_f32_16x16x32_bf16 v[36:39], v[140:143], v[112:115], v[36:39]
    ds_read_b128 v[184:187], v3 offset:36864
    v_mfma_f32_16x16x32_bf16 v[52:55], v[140:143], v[116:119], v[52:55]
    ds_read_b128 v[188:191], v3 offset:38912
    v_mfma_f32_16x16x32_bf16 v[68:71], v[140:143], v[120:123], v[68:71]
    ds_read_b64_tr_b16 v[204:205], v5 offset:40960
    v_mfma_f32_16x16x32_bf16 v[84:87], v[140:143], v[124:127], v[84:87]
    ds_read_b64_tr_b16 v[206:207], v5 offset:41984
    v_mfma_f32_16x16x32_bf16 v[40:43], v[148:151], v[112:115], v[40:43]
    ds_read_b64_tr_b16 v[212:213], v6 offset:40960
    v_mfma_f32_16x16x32_bf16 v[56:59], v[148:151], v[116:119], v[56:59]
    ds_read_b64_tr_b16 v[214:215], v6 offset:41984
    v_mfma_f32_16x16x32_bf16 v[72:75], v[148:151], v[120:123], v[72:75]
    ds_read_b64_tr_b16 v[220:221], v7 offset:40960
    v_mfma_f32_16x16x32_bf16 v[88:91], v[148:151], v[124:127], v[88:91]
    ds_read_b64_tr_b16 v[222:223], v7 offset:41984
    v_mfma_f32_16x16x32_bf16 v[44:47], v[156:159], v[112:115], v[44:47]
    v_mfma_f32_16x16x32_bf16 v[60:63], v[156:159], v[116:119], v[60:63]
    v_mfma_f32_16x16x32_bf16 v[76:79], v[156:159], v[120:123], v[76:79]
    v_mfma_f32_16x16x32_bf16 v[92:95], v[156:159], v[124:127], v[92:95]
    s_waitcnt lgkmcnt(14)
    v_mfma_f32_16x16x32_bf16 v[32:35], v[192:195], v[160:163], v[32:35]
    v_xor_b32 v2, 0x10000, v2
    v_mfma_f32_16x16x32_bf16 v[48:51], v[192:195], v[164:167], v[48:51]
    v_xor_b32 v3, 0x10000, v3
    v_mfma_f32_16x16x32_bf16 v[64:67], v[192:195], v[168:171], v[64:67]
    v_xor_b32 v4, 0x10000, v4
    v_mfma_f32_16x16x32_bf16 v[80:83], v[192:195], v[172:175], v[80:83]
    v_xor_b32 v5, 0x10000, v5
    v_mfma_f32_16x16x32_bf16 v[36:39], v[200:203], v[160:163], v[36:39]
    v_xor_b32 v6, 0x10000, v6
    v_mfma_f32_16x16x32_bf16 v[52:55], v[200:203], v[164:167], v[52:55]
    v_xor_b32 v7, 0x10000, v7
    v_mfma_f32_16x16x32_bf16 v[68:71], v[200:203], v[168:171], v[68:71]
    s_waitcnt lgkmcnt(0)
    s_barrier
    ds_read_b64_tr_b16 v[128:129], v4 offset:0
    v_smfmac_f32_16x16x64_bf16 v[240:243], v[12:15], v[192:199], v18
    ds_read_b64_tr_b16 v[130:131], v4 offset:1024
    v_mfma_f32_16x16x32_bf16 v[84:87], v[200:203], v[172:175], v[84:87]
    ds_read_b128 v[96:99], v2 offset:0
    v_smfmac_f32_16x16x64_bf16 v[244:247], v[12:15], v[200:207], v18
    ds_read_b128 v[100:103], v2 offset:2048
    v_mfma_f32_16x16x32_bf16 v[40:43], v[208:211], v[160:163], v[40:43]
    ds_read_b128 v[104:107], v2 offset:4096
    v_mfma_f32_16x16x32_bf16 v[56:59], v[208:211], v[164:167], v[56:59]
    ds_read_b128 v[108:111], v2 offset:6144
    v_mfma_f32_16x16x32_bf16 v[72:75], v[208:211], v[168:171], v[72:75]
    ds_read_b64_tr_b16 v[136:137], v5 offset:0
    v_mfma_f32_16x16x32_bf16 v[88:91], v[208:211], v[172:175], v[88:91]
    ds_read_b64_tr_b16 v[138:139], v5 offset:1024
    v_mfma_f32_16x16x32_bf16 v[44:47], v[216:219], v[160:163], v[44:47]
    ds_read_b64_tr_b16 v[144:145], v6 offset:0
    v_mfma_f32_16x16x32_bf16 v[60:63], v[216:219], v[164:167], v[60:63]
    ds_read_b64_tr_b16 v[146:147], v6 offset:1024
    v_mfma_f32_16x16x32_bf16 v[76:79], v[216:219], v[168:171], v[76:79]
    ds_read_b64_tr_b16 v[152:153], v7 offset:0
    v_mfma_f32_16x16x32_bf16 v[92:95], v[216:219], v[172:175], v[92:95]
    ds_read_b64_tr_b16 v[154:155], v7 offset:1024
    v_mfma_f32_16x16x32_bf16 v[32:35], v[196:199], v[176:179], v[32:35]
    ds_read_b64_tr_b16 v[132:133], v4 offset:8192
    v_mfma_f32_16x16x32_bf16 v[48:51], v[196:199], v[180:183], v[48:51]
    ds_read_b64_tr_b16 v[134:135], v4 offset:9216
    v_mfma_f32_16x16x32_bf16 v[64:67], v[196:199], v[184:187], v[64:67]
    ds_read_b128 v[112:115], v3 offset:0
    v_mfma_f32_16x16x32_bf16 v[80:83], v[196:199], v[188:191], v[80:83]
    ds_read_b128 v[116:119], v3 offset:2048
    v_mfma_f32_16x16x32_bf16 v[36:39], v[204:207], v[176:179], v[36:39]
    ds_read_b128 v[120:123], v3 offset:4096
    v_mfma_f32_16x16x32_bf16 v[52:55], v[204:207], v[180:183], v[52:55]
    ds_read_b128 v[124:127], v3 offset:6144
    v_mfma_f32_16x16x32_bf16 v[68:71], v[204:207], v[184:187], v[68:71]
    ds_read_b64_tr_b16 v[140:141], v5 offset:8192
    v_mfma_f32_16x16x32_bf16 v[84:87], v[204:207], v[188:191], v[84:87]
    ds_read_b64_tr_b16 v[142:143], v5 offset:9216
    v_mfma_f32_16x16x32_bf16 v[40:43], v[212:215], v[176:179], v[40:43]
    ds_read_b64_tr_b16 v[148:149], v6 offset:8192
    v_mfma_f32_16x16x32_bf16 v[56:59], v[212:215], v[180:183], v[56:59]
    ds_read_b64_tr_b16 v[150:151], v6 offset:9216
    v_mfma_f32_16x16x32_bf16 v[72:75], v[212:215], v[184:187], v[72:75]
    ds_read_b64_tr_b16 v[156:157], v7 offset:8192
    v_mfma_f32_16x16x32_bf16 v[88:91], v[212:215], v[188:191], v[88:91]
    ds_read_b64_tr_b16 v[158:159], v7 offset:9216
    v_mfma_f32_16x16x32_bf16 v[44:47], v[220:223], v[176:179], v[44:47]
    v_mfma_f32_16x16x32_bf16 v[60:63], v[220:223], v[180:183], v[60:63]
    v_mfma_f32_16x16x32_bf16 v[76:79], v[220:223], v[184:187], v[76:79]
    v_mfma_f32_16x16x32_bf16 v[92:95], v[220:223], v[188:191], v[92:95]
    s_waitcnt lgkmcnt(14)
    v_mfma_f32_16x16x32_bf16 v[32:35], v[128:131], v[96:99], v[32:35]
    ds_read_b32 v224, v19 offset:0
    v_mfma_f32_16x16x32_bf16 v[48:51], v[128:131], v[100:103], v[48:51]
    ds_read_b32 v225, v19 offset:128
    v_mfma_f32_16x16x32_bf16 v[64:67], v[128:131], v[104:107], v[64:67]
    ds_read_b32 v226, v19 offset:256
    v_mfma_f32_16x16x32_bf16 v[80:83], v[128:131], v[108:111], v[80:83]
    ds_read_b32 v227, v19 offset:384
    v_mfma_f32_16x16x32_bf16 v[36:39], v[136:139], v[96:99], v[36:39]
    ds_read_b32 v228, v1
    v_mfma_f32_16x16x32_bf16 v[52:55], v[136:139], v[100:103], v[52:55]
    v_mfma_f32_16x16x32_bf16 v[68:71], v[136:139], v[104:107], v[68:71]
    s_waitcnt lgkmcnt(0)
    s_barrier
    ds_read_b64_tr_b16 v[192:193], v4 offset:32768
    v_smfmac_f32_16x16x64_bf16 v[240:243], v[12:15], v[128:135], v18
    ds_read_b64_tr_b16 v[194:195], v4 offset:33792
    v_cndmask_b32 v233, 0, v224, s[100:101]
    v_mfma_f32_16x16x32_bf16 v[84:87], v[136:139], v[108:111], v[84:87]
    ds_read_b128 v[160:163], v2 offset:32768
    v_and_b32 v28, s55, v224
    v_smfmac_f32_16x16x64_bf16 v[244:247], v[12:15], v[136:143], v18
    ds_read_b128 v[164:167], v2 offset:34816
    v_perm_b32 v232, v233, v233, s40
    v_mfma_f32_16x16x32_bf16 v[40:43], v[144:147], v[96:99], v[40:43]
    ds_read_b128 v[168:171], v2 offset:36864
    v_rcp_f32 v224, v28
    v_mfma_f32_16x16x32_bf16 v[56:59], v[144:147], v[100:103], v[56:59]
    ds_read_b128 v[172:175], v2 offset:38912
    v_cndmask_b32 v235, 0, v225, s[100:101]
    v_mfma_f32_16x16x32_bf16 v[72:75], v[144:147], v[104:107], v[72:75]
    ds_read_b64_tr_b16 v[200:201], v5 offset:32768
    v_and_b32 v29, s55, v225
    v_mfma_f32_16x16x32_bf16 v[88:91], v[144:147], v[108:111], v[88:91]
    ds_read_b64_tr_b16 v[202:203], v5 offset:33792
    v_perm_b32 v234, v235, v235, s40
    v_mfma_f32_16x16x32_bf16 v[44:47], v[152:155], v[96:99], v[44:47]
    ds_read_b64_tr_b16 v[208:209], v6 offset:32768
    v_rcp_f32 v225, v29
    v_mfma_f32_16x16x32_bf16 v[60:63], v[152:155], v[100:103], v[60:63]
    ds_read_b64_tr_b16 v[210:211], v6 offset:33792
    v_cndmask_b32 v237, 0, v226, s[100:101]
    v_mfma_f32_16x16x32_bf16 v[76:79], v[152:155], v[104:107], v[76:79]
    ds_read_b64_tr_b16 v[216:217], v7 offset:32768
    v_and_b32 v30, s55, v226
    v_mfma_f32_16x16x32_bf16 v[92:95], v[152:155], v[108:111], v[92:95]
    ds_read_b64_tr_b16 v[218:219], v7 offset:33792
    v_perm_b32 v236, v237, v237, s40
    v_mfma_f32_16x16x32_bf16 v[32:35], v[132:135], v[112:115], v[32:35]
    ds_read_b64_tr_b16 v[196:197], v4 offset:40960
    v_rcp_f32 v226, v30
    v_mfma_f32_16x16x32_bf16 v[48:51], v[132:135], v[116:119], v[48:51]
    ds_read_b64_tr_b16 v[198:199], v4 offset:41984
    v_cndmask_b32 v239, 0, v227, s[100:101]
    v_mfma_f32_16x16x32_bf16 v[64:67], v[132:135], v[120:123], v[64:67]
    ds_read_b128 v[176:179], v3 offset:32768
    v_and_b32 v31, s55, v227
    v_mfma_f32_16x16x32_bf16 v[80:83], v[132:135], v[124:127], v[80:83]
    ds_read_b128 v[180:183], v3 offset:34816
    v_perm_b32 v238, v239, v239, s40
    v_mfma_f32_16x16x32_bf16 v[36:39], v[140:143], v[112:115], v[36:39]
    ds_read_b128 v[184:187], v3 offset:36864
    v_rcp_f32 v227, v31
    v_mfma_f32_16x16x32_bf16 v[52:55], v[140:143], v[116:119], v[52:55]
    ds_read_b128 v[188:191], v3 offset:38912
    v_readfirstlane_b32 s60, v228
    v_mfma_f32_16x16x32_bf16 v[68:71], v[140:143], v[120:123], v[68:71]
    ds_read_b64_tr_b16 v[204:205], v5 offset:40960
    v_mul_f32 v20, 0xc0135761, v224
    v_mfma_f32_16x16x32_bf16 v[84:87], v[140:143], v[124:127], v[84:87]
    ds_read_b64_tr_b16 v[206:207], v5 offset:41984
    v_mul_f32 v21, v224, v224
    v_mfma_f32_16x16x32_bf16 v[40:43], v[148:151], v[112:115], v[40:43]
    ds_read_b64_tr_b16 v[212:213], v6 offset:40960
    v_mul_f32 v224, 0xbdd2d3e8, v224
    v_mfma_f32_16x16x32_bf16 v[56:59], v[148:151], v[116:119], v[56:59]
    ds_read_b64_tr_b16 v[214:215], v6 offset:41984
    v_mul_f32 v21, v21, v224
    v_mfma_f32_16x16x32_bf16 v[72:75], v[148:151], v[120:123], v[72:75]
    ds_read_b64_tr_b16 v[220:221], v7 offset:40960
    v_mul_f32 v22, 0xc0135761, v225
    v_mfma_f32_16x16x32_bf16 v[88:91], v[148:151], v[124:127], v[88:91]
    ds_read_b64_tr_b16 v[222:223], v7 offset:41984
    v_mul_f32 v23, v225, v225
    v_mfma_f32_16x16x32_bf16 v[44:47], v[156:159], v[112:115], v[44:47]
    v_mul_f32 v225, 0xbdd2d3e8, v225
    v_mul_f32 v23, v23, v225
    v_mfma_f32_16x16x32_bf16 v[60:63], v[156:159], v[116:119], v[60:63]
    v_mul_f32 v24, 0xc0135761, v226
    v_mul_f32 v25, v226, v226
    v_mfma_f32_16x16x32_bf16 v[76:79], v[156:159], v[120:123], v[76:79]
    v_mul_f32 v226, 0xbdd2d3e8, v226
    v_mul_f32 v25, v25, v226
    v_mfma_f32_16x16x32_bf16 v[92:95], v[156:159], v[124:127], v[92:95]
    v_mul_f32 v26, 0xc0135761, v227
    v_mul_f32 v27, v227, v227
    s_waitcnt lgkmcnt(14)
    v_mfma_f32_16x16x32_bf16 v[32:35], v[192:195], v[160:163], v[32:35]
    v_mul_f32 v227, 0xbdd2d3e8, v227
    v_mul_f32 v27, v27, v227
    v_mfma_f32_16x16x32_bf16 v[48:51], v[192:195], v[164:167], v[48:51]
    s_andn2_b32 s60, s60, 7
    s_or_b32 s43, s60, s41
    v_mfma_f32_16x16x32_bf16 v[64:67], v[192:195], v[168:171], v[64:67]
    v_cmp_ne_u32 s[98:99], s43, v228
    v_mfma_f32_16x16x32_bf16 v[80:83], v[192:195], v[172:175], v[80:83]
    v_mfma_f32_16x16x32_bf16 v[36:39], v[200:203], v[160:163], v[36:39]
    v_mfma_f32_16x16x32_bf16 v[52:55], v[200:203], v[164:167], v[52:55]
    v_mfma_f32_16x16x32_bf16 v[68:71], v[200:203], v[168:171], v[68:71]
    s_waitcnt lgkmcnt(0)
    s_barrier
    v_xor_b32 v19, 96, v8
    ds_read_b64_tr_b16 v[96:97], v8 offset:0
    v_and_b32 v6, 7, v0
    v_lshlrev_b32 v6, 4, v6
    s_lshl_b32 s43, s7, 7
    buffer_load_dwordx4 v[2:5], v6, s[36:39], s43 offen
    v_smfmac_f32_16x16x64_bf16 v[240:243], v[12:15], v[192:199], v18
    ds_read_b64_tr_b16 v[98:99], v8 offset:2048
    v_mfma_f32_16x16x32_bf16 v[84:87], v[200:203], v[172:175], v[84:87]
    ds_read_b64_tr_b16 v[100:101], v9 offset:0
    v_smfmac_f32_16x16x64_bf16 v[244:247], v[12:15], v[200:207], v18
    ds_read_b64_tr_b16 v[102:103], v9 offset:2048
    ds_read_b64_tr_b16 v[104:105], v10 offset:0
    v_mfma_f32_16x16x32_bf16 v[40:43], v[208:211], v[160:163], v[40:43]
    ds_read_b64_tr_b16 v[106:107], v10 offset:2048
    v_mfma_f32_16x16x32_bf16 v[56:59], v[208:211], v[164:167], v[56:59]
    ds_read_b64_tr_b16 v[108:109], v19 offset:0
    v_mfma_f32_16x16x32_bf16 v[72:75], v[208:211], v[168:171], v[72:75]
    ds_read_b64_tr_b16 v[110:111], v19 offset:2048
    ds_read_b64_tr_b16 v[112:113], v8 offset:8192
    v_mfma_f32_16x16x32_bf16 v[88:91], v[208:211], v[172:175], v[88:91]
    ds_read_b64_tr_b16 v[114:115], v8 offset:10240
    v_mfma_f32_16x16x32_bf16 v[44:47], v[216:219], v[160:163], v[44:47]
    ds_read_b64_tr_b16 v[116:117], v9 offset:8192
    v_mfma_f32_16x16x32_bf16 v[60:63], v[216:219], v[164:167], v[60:63]
    ds_read_b64_tr_b16 v[118:119], v9 offset:10240
    ds_read_b64_tr_b16 v[120:121], v10 offset:8192
    v_mfma_f32_16x16x32_bf16 v[76:79], v[216:219], v[168:171], v[76:79]
    ds_read_b64_tr_b16 v[122:123], v10 offset:10240
    v_mfma_f32_16x16x32_bf16 v[92:95], v[216:219], v[172:175], v[92:95]
    ds_read_b64_tr_b16 v[124:125], v19 offset:8192
    v_mfma_f32_16x16x32_bf16 v[32:35], v[196:199], v[176:179], v[32:35]
    ds_read_b64_tr_b16 v[126:127], v19 offset:10240
    v_add_u32 v8, 0xfffe0000, v8
    s_waitcnt vmcnt(1)
    v_add_f32 v240, v240, v241
    v_mfma_f32_16x16x32_bf16 v[48:51], v[196:199], v[180:183], v[48:51]
    v_add_u32 v9, 0xfffe0000, v9
    v_and_b32 v241, s55, v240
    v_mfma_f32_16x16x32_bf16 v[64:67], v[196:199], v[184:187], v[64:67]
    v_add_u32 v10, 0xfffe0000, v10
    v_sub_f32 v241, v240, v241
    v_mfma_f32_16x16x32_bf16 v[80:83], v[196:199], v[188:191], v[80:83]
    v_add_u32 v19, 0xfffe0000, v19
    ds_read_b64_tr_b16 v[128:129], v8 offset:0
    v_and_b32 v242, s55, v241
    v_mfma_f32_16x16x32_bf16 v[36:39], v[204:207], v[176:179], v[36:39]
    ds_read_b64_tr_b16 v[130:131], v8 offset:2048
    v_sub_f32 v242, v241, v242
    v_mfma_f32_16x16x32_bf16 v[52:55], v[204:207], v[180:183], v[52:55]
    ds_read_b64_tr_b16 v[132:133], v9 offset:0
    v_perm_b32 v243, v229, v242, s13
    v_mfma_f32_16x16x32_bf16 v[68:71], v[204:207], v[184:187], v[68:71]
    ds_read_b64_tr_b16 v[134:135], v9 offset:2048
    ds_read_b64_tr_b16 v[136:137], v10 offset:0
    v_perm_b32 v242, v241, v240, s12
    v_mfma_f32_16x16x32_bf16 v[84:87], v[204:207], v[188:191], v[84:87]
    ds_read_b64_tr_b16 v[138:139], v10 offset:2048
    v_add_f32 v244, v244, v245
    v_mfma_f32_16x16x32_bf16 v[40:43], v[212:215], v[176:179], v[40:43]
    ds_read_b64_tr_b16 v[140:141], v19 offset:0
    v_and_b32 v245, s55, v244
    v_sub_f32 v245, v244, v245
    v_mfma_f32_16x16x32_bf16 v[56:59], v[212:215], v[180:183], v[56:59]
    ds_read_b64_tr_b16 v[142:143], v19 offset:2048
    ds_read_b64_tr_b16 v[144:145], v8 offset:8192
    v_and_b32 v246, s55, v245
    v_mfma_f32_16x16x32_bf16 v[72:75], v[212:215], v[184:187], v[72:75]
    ds_read_b64_tr_b16 v[146:147], v8 offset:10240
    v_sub_f32 v246, v245, v246
    v_mfma_f32_16x16x32_bf16 v[88:91], v[212:215], v[188:191], v[88:91]
    ds_read_b64_tr_b16 v[148:149], v9 offset:8192
    v_perm_b32 v247, v230, v246, s13
    v_mfma_f32_16x16x32_bf16 v[44:47], v[220:223], v[176:179], v[44:47]
    ds_read_b64_tr_b16 v[150:151], v9 offset:10240
    ds_read_b64_tr_b16 v[152:153], v10 offset:8192
    v_perm_b32 v246, v245, v244, s12
    v_mfma_f32_16x16x32_bf16 v[60:63], v[220:223], v[180:183], v[60:63]
    ds_read_b64_tr_b16 v[154:155], v10 offset:10240
    ds_write2_b64 v231, v[242:243], v[246:247] offset0:0 offset1:1
    v_mfma_f32_16x16x32_bf16 v[76:79], v[220:223], v[184:187], v[76:79]
    ds_read_b64_tr_b16 v[156:157], v19 offset:8192
    v_xor_b32 v1, 2048, v231
    v_mfma_f32_16x16x32_bf16 v[92:95], v[220:223], v[188:191], v[92:95]
    ds_read_b64_tr_b16 v[158:159], v19 offset:10240
    v_mov_b32 v18, s60
    s_nop 0
    v_mfma_f32_16x16x16_bf16 v[32:35], v[242:243], v[232:233], v[32:35]
    v_mfma_f32_16x16x16_bf16 v[36:39], v[246:247], v[232:233], v[36:39]
    v_mfma_f32_16x16x16_bf16 v[48:51], v[242:243], v[234:235], v[48:51]
    v_mfma_f32_16x16x16_bf16 v[52:55], v[246:247], v[234:235], v[52:55]
    v_mfma_f32_16x16x16_bf16 v[64:67], v[242:243], v[236:237], v[64:67]
    v_mfma_f32_16x16x16_bf16 v[68:71], v[246:247], v[236:237], v[68:71]
    v_mfma_f32_16x16x16_bf16 v[80:83], v[242:243], v[238:239], v[80:83]
    v_mfma_f32_16x16x16_bf16 v[84:87], v[246:247], v[238:239], v[84:87]
    s_nop 1
    v_pk_mul_f32 v[224:225], v[32:33], v[32:33]
    v_pk_mul_f32 v[226:227], v[34:35], v[34:35]
    v_pk_mul_f32 v[228:229], v[36:37], v[36:37]
    v_pk_mul_f32 v[230:231], v[38:39], v[38:39]
    v_pk_fma_f32 v[224:225], v[224:225], v[20:21], v[20:21] op_sel:[0,1,0] op_sel_hi:[1,1,0]
    v_pk_fma_f32 v[226:227], v[226:227], v[20:21], v[20:21] op_sel:[0,1,0] op_sel_hi:[1,1,0]
    v_pk_fma_f32 v[228:229], v[228:229], v[20:21], v[20:21] op_sel:[0,1,0] op_sel_hi:[1,1,0]
    v_pk_fma_f32 v[230:231], v[230:231], v[20:21], v[20:21] op_sel:[0,1,0] op_sel_hi:[1,1,0]
    v_pk_mul_f32 v[224:225], v[32:33], v[224:225]
    v_pk_mul_f32 v[226:227], v[34:35], v[226:227]
    v_pk_mul_f32 v[228:229], v[36:37], v[228:229]
    v_pk_mul_f32 v[230:231], v[38:39], v[230:231]
    v_exp_f32 v224, v224
    v_exp_f32 v225, v225
    v_exp_f32 v226, v226
    v_exp_f32 v227, v227
    v_exp_f32 v228, v228
    v_exp_f32 v229, v229
    v_exp_f32 v230, v230
    v_exp_f32 v231, v231
    v_pk_fma_f32 v[224:225], v[224:225], v[28:29], v[28:29] op_sel_hi:[1,0,0]
    v_pk_fma_f32 v[226:227], v[226:227], v[28:29], v[28:29] op_sel_hi:[1,0,0]
    v_pk_fma_f32 v[228:229], v[228:229], v[28:29], v[28:29] op_sel_hi:[1,0,0]
    v_pk_fma_f32 v[230:231], v[230:231], v[28:29], v[28:29] op_sel_hi:[1,0,0]
    v_rcp_f32 v224, v224
    v_rcp_f32 v225, v225
    v_rcp_f32 v226, v226
    v_rcp_f32 v227, v227
    v_rcp_f32 v228, v228
    v_rcp_f32 v229, v229
    v_rcp_f32 v230, v230
    v_rcp_f32 v231, v231
    v_pk_mul_f32 v[224:225], v[32:33], v[224:225]
    v_pk_mul_f32 v[226:227], v[34:35], v[226:227]
    v_pk_mul_f32 v[228:229], v[36:37], v[228:229]
    v_pk_mul_f32 v[230:231], v[38:39], v[230:231]
    v_cvt_pk_bf16_f32 v248, v224, v225
    v_cvt_pk_bf16_f32 v249, v226, v227
    v_cvt_pk_bf16_f32 v250, v228, v229
    v_cvt_pk_bf16_f32 v251, v230, v231
    s_add_u32 s43, s51, 0
    buffer_store_dwordx4 v[248:251], v11, s[20:23], s43 offen offset:0 sc1
    s_waitcnt lgkmcnt(0)
    v_pk_mul_f32 v[224:225], v[48:49], v[48:49]
    v_pk_mul_f32 v[226:227], v[50:51], v[50:51]
    v_pk_mul_f32 v[228:229], v[52:53], v[52:53]
    v_pk_mul_f32 v[230:231], v[54:55], v[54:55]
    v_pk_fma_f32 v[224:225], v[224:225], v[22:23], v[22:23] op_sel:[0,1,0] op_sel_hi:[1,1,0]
    v_pk_fma_f32 v[226:227], v[226:227], v[22:23], v[22:23] op_sel:[0,1,0] op_sel_hi:[1,1,0]
    v_pk_fma_f32 v[228:229], v[228:229], v[22:23], v[22:23] op_sel:[0,1,0] op_sel_hi:[1,1,0]
    v_pk_fma_f32 v[230:231], v[230:231], v[22:23], v[22:23] op_sel:[0,1,0] op_sel_hi:[1,1,0]
    v_pk_mul_f32 v[224:225], v[48:49], v[224:225]
    v_pk_mul_f32 v[226:227], v[50:51], v[226:227]
    v_pk_mul_f32 v[228:229], v[52:53], v[228:229]
    v_pk_mul_f32 v[230:231], v[54:55], v[230:231]
    v_exp_f32 v224, v224
    v_exp_f32 v225, v225
    v_exp_f32 v226, v226
    v_exp_f32 v227, v227
    v_exp_f32 v228, v228
    v_exp_f32 v229, v229
    v_exp_f32 v230, v230
    v_exp_f32 v231, v231
    v_pk_fma_f32 v[224:225], v[224:225], v[28:29], v[28:29] op_sel:[0,1,1] op_sel_hi:[1,1,1]
    v_pk_fma_f32 v[226:227], v[226:227], v[28:29], v[28:29] op_sel:[0,1,1] op_sel_hi:[1,1,1]
    v_pk_fma_f32 v[228:229], v[228:229], v[28:29], v[28:29] op_sel:[0,1,1] op_sel_hi:[1,1,1]
    v_pk_fma_f32 v[230:231], v[230:231], v[28:29], v[28:29] op_sel:[0,1,1] op_sel_hi:[1,1,1]
    v_rcp_f32 v224, v224
    v_rcp_f32 v225, v225
    v_rcp_f32 v226, v226
    v_rcp_f32 v227, v227
    v_rcp_f32 v228, v228
    v_rcp_f32 v229, v229
    v_rcp_f32 v230, v230
    v_rcp_f32 v231, v231
    v_pk_mul_f32 v[224:225], v[48:49], v[224:225]
    v_pk_mul_f32 v[226:227], v[50:51], v[226:227]
    v_pk_mul_f32 v[228:229], v[52:53], v[228:229]
    v_pk_mul_f32 v[230:231], v[54:55], v[230:231]
    v_cvt_pk_bf16_f32 v240, v224, v225
    v_cvt_pk_bf16_f32 v241, v226, v227
    v_cvt_pk_bf16_f32 v242, v228, v229
    v_cvt_pk_bf16_f32 v243, v230, v231
    s_add_u32 s43, s51, 0
    buffer_store_dwordx4 v[240:243], v11, s[20:23], s43 offen offset:1024 sc1
    v_pk_mul_f32 v[224:225], v[64:65], v[64:65]
    v_pk_mul_f32 v[226:227], v[66:67], v[66:67]
    v_pk_mul_f32 v[228:229], v[68:69], v[68:69]
    v_pk_mul_f32 v[230:231], v[70:71], v[70:71]
    v_pk_fma_f32 v[224:225], v[224:225], v[24:25], v[24:25] op_sel:[0,1,0] op_sel_hi:[1,1,0]
    v_pk_fma_f32 v[226:227], v[226:227], v[24:25], v[24:25] op_sel:[0,1,0] op_sel_hi:[1,1,0]
    v_pk_fma_f32 v[228:229], v[228:229], v[24:25], v[24:25] op_sel:[0,1,0] op_sel_hi:[1,1,0]
    v_pk_fma_f32 v[230:231], v[230:231], v[24:25], v[24:25] op_sel:[0,1,0] op_sel_hi:[1,1,0]
    v_pk_mul_f32 v[224:225], v[64:65], v[224:225]
    v_pk_mul_f32 v[226:227], v[66:67], v[226:227]
    v_pk_mul_f32 v[228:229], v[68:69], v[228:229]
    v_pk_mul_f32 v[230:231], v[70:71], v[230:231]
    v_exp_f32 v224, v224
    v_exp_f32 v225, v225
    v_exp_f32 v226, v226
    v_exp_f32 v227, v227
    v_exp_f32 v228, v228
    v_exp_f32 v229, v229
    v_exp_f32 v230, v230
    v_exp_f32 v231, v231
    v_pk_fma_f32 v[224:225], v[224:225], v[30:31], v[30:31] op_sel_hi:[1,0,0]
    v_pk_fma_f32 v[226:227], v[226:227], v[30:31], v[30:31] op_sel_hi:[1,0,0]
    v_pk_fma_f32 v[228:229], v[228:229], v[30:31], v[30:31] op_sel_hi:[1,0,0]
    v_pk_fma_f32 v[230:231], v[230:231], v[30:31], v[30:31] op_sel_hi:[1,0,0]
    v_rcp_f32 v224, v224
    v_rcp_f32 v225, v225
    v_rcp_f32 v226, v226
    v_rcp_f32 v227, v227
    v_rcp_f32 v228, v228
    v_rcp_f32 v229, v229
    v_rcp_f32 v230, v230
    v_rcp_f32 v231, v231
    v_pk_mul_f32 v[224:225], v[64:65], v[224:225]
    v_pk_mul_f32 v[226:227], v[66:67], v[226:227]
    v_pk_mul_f32 v[228:229], v[68:69], v[228:229]
    v_pk_mul_f32 v[230:231], v[70:71], v[230:231]
    v_cvt_pk_bf16_f32 v244, v224, v225
    v_cvt_pk_bf16_f32 v245, v226, v227
    v_cvt_pk_bf16_f32 v246, v228, v229
    v_cvt_pk_bf16_f32 v247, v230, v231
    s_add_u32 s43, s51, 114688
    buffer_store_dwordx4 v[244:247], v11, s[20:23], s43 offen offset:0 sc1
    v_pk_mul_f32 v[224:225], v[80:81], v[80:81]
    v_pk_mul_f32 v[226:227], v[82:83], v[82:83]
    v_pk_mul_f32 v[228:229], v[84:85], v[84:85]
    v_pk_mul_f32 v[230:231], v[86:87], v[86:87]
    v_pk_fma_f32 v[224:225], v[224:225], v[26:27], v[26:27] op_sel:[0,1,0] op_sel_hi:[1,1,0]
    v_pk_fma_f32 v[226:227], v[226:227], v[26:27], v[26:27] op_sel:[0,1,0] op_sel_hi:[1,1,0]
    v_pk_fma_f32 v[228:229], v[228:229], v[26:27], v[26:27] op_sel:[0,1,0] op_sel_hi:[1,1,0]
    v_pk_fma_f32 v[230:231], v[230:231], v[26:27], v[26:27] op_sel:[0,1,0] op_sel_hi:[1,1,0]
    v_pk_mul_f32 v[224:225], v[80:81], v[224:225]
    v_pk_mul_f32 v[226:227], v[82:83], v[226:227]
    v_pk_mul_f32 v[228:229], v[84:85], v[228:229]
    v_pk_mul_f32 v[230:231], v[86:87], v[230:231]
    v_exp_f32 v224, v224
    v_exp_f32 v225, v225
    v_exp_f32 v226, v226
    v_exp_f32 v227, v227
    v_exp_f32 v228, v228
    v_exp_f32 v229, v229
    v_exp_f32 v230, v230
    v_exp_f32 v231, v231
    v_pk_fma_f32 v[224:225], v[224:225], v[30:31], v[30:31] op_sel:[0,1,1] op_sel_hi:[1,1,1]
    v_pk_fma_f32 v[226:227], v[226:227], v[30:31], v[30:31] op_sel:[0,1,1] op_sel_hi:[1,1,1]
    v_pk_fma_f32 v[228:229], v[228:229], v[30:31], v[30:31] op_sel:[0,1,1] op_sel_hi:[1,1,1]
    v_pk_fma_f32 v[230:231], v[230:231], v[30:31], v[30:31] op_sel:[0,1,1] op_sel_hi:[1,1,1]
    v_rcp_f32 v224, v224
    v_rcp_f32 v225, v225
    v_rcp_f32 v226, v226
    v_rcp_f32 v227, v227
    v_rcp_f32 v228, v228
    v_rcp_f32 v229, v229
    v_rcp_f32 v230, v230
    v_rcp_f32 v231, v231
    v_pk_mul_f32 v[224:225], v[80:81], v[224:225]
    v_pk_mul_f32 v[226:227], v[82:83], v[226:227]
    v_pk_mul_f32 v[228:229], v[84:85], v[228:229]
    v_pk_mul_f32 v[230:231], v[86:87], v[230:231]
    v_cvt_pk_bf16_f32 v248, v224, v225
    v_cvt_pk_bf16_f32 v249, v226, v227
    v_cvt_pk_bf16_f32 v250, v228, v229
    v_cvt_pk_bf16_f32 v251, v230, v231
    s_add_u32 s43, s51, 114688
    buffer_store_dwordx4 v[248:251], v11, s[20:23], s43 offen offset:1024 sc1
    s_barrier
    ds_read_b128 v[252:255], v1
    ds_read_b64_tr_b16 v[160:161], v8 offset:16384
    ds_read_b64_tr_b16 v[162:163], v8 offset:18432
    ds_read_b64_tr_b16 v[164:165], v9 offset:16384
    ds_read_b64_tr_b16 v[166:167], v9 offset:18432
    ds_read_b64_tr_b16 v[168:169], v10 offset:16384
    ds_read_b64_tr_b16 v[170:171], v10 offset:18432
    ds_read_b64_tr_b16 v[172:173], v19 offset:16384
    ds_read_b64_tr_b16 v[174:175], v19 offset:18432
    ds_read_b64_tr_b16 v[176:177], v8 offset:24576
    ds_read_b64_tr_b16 v[178:179], v8 offset:26624
    ds_read_b64_tr_b16 v[180:181], v9 offset:24576
    ds_read_b64_tr_b16 v[182:183], v9 offset:26624
    ds_read_b64_tr_b16 v[184:185], v10 offset:24576
    ds_read_b64_tr_b16 v[186:187], v10 offset:26624
    ds_read_b64_tr_b16 v[188:189], v19 offset:24576
    ds_read_b64_tr_b16 v[190:191], v19 offset:26624
    ds_read_b64_tr_b16 v[192:193], v8 offset:32768
    ds_read_b64_tr_b16 v[194:195], v8 offset:34816
    ds_read_b64_tr_b16 v[196:197], v9 offset:32768
    ds_read_b64_tr_b16 v[198:199], v9 offset:34816
    ds_read_b64_tr_b16 v[200:201], v10 offset:32768
    ds_read_b64_tr_b16 v[202:203], v10 offset:34816
    ds_read_b64_tr_b16 v[204:205], v19 offset:32768
    ds_read_b64_tr_b16 v[206:207], v19 offset:34816
    ds_read_b64_tr_b16 v[208:209], v8 offset:40960
    ds_read_b64_tr_b16 v[210:211], v8 offset:43008
    ds_read_b64_tr_b16 v[212:213], v9 offset:40960
    ds_read_b64_tr_b16 v[214:215], v9 offset:43008
    ds_read_b64_tr_b16 v[216:217], v10 offset:40960
    ds_read_b64_tr_b16 v[218:219], v10 offset:43008
    ds_read_b64_tr_b16 v[220:221], v19 offset:40960
    ds_read_b64_tr_b16 v[222:223], v19 offset:43008
    s_waitcnt lgkmcnt(14)
    v_mfma_f32_16x16x16_bf16 v[40:43], v[252:253], v[232:233], v[40:43]
    v_mfma_f32_16x16x16_bf16 v[44:47], v[254:255], v[232:233], v[44:47]
    v_mfma_f32_16x16x16_bf16 v[56:59], v[252:253], v[234:235], v[56:59]
    v_mfma_f32_16x16x16_bf16 v[60:63], v[254:255], v[234:235], v[60:63]
    v_mfma_f32_16x16x16_bf16 v[72:75], v[252:253], v[236:237], v[72:75]
    v_mfma_f32_16x16x16_bf16 v[76:79], v[254:255], v[236:237], v[76:79]
    v_mfma_f32_16x16x16_bf16 v[88:91], v[252:253], v[238:239], v[88:91]
    v_mfma_f32_16x16x16_bf16 v[92:95], v[254:255], v[238:239], v[92:95]
    s_nop 1
    v_pk_mul_f32 v[224:225], v[40:41], v[40:41]
    v_pk_mul_f32 v[226:227], v[42:43], v[42:43]
    v_pk_mul_f32 v[228:229], v[44:45], v[44:45]
    v_pk_mul_f32 v[230:231], v[46:47], v[46:47]
    v_pk_fma_f32 v[224:225], v[224:225], v[20:21], v[20:21] op_sel:[0,1,0] op_sel_hi:[1,1,0]
    v_pk_fma_f32 v[226:227], v[226:227], v[20:21], v[20:21] op_sel:[0,1,0] op_sel_hi:[1,1,0]
    v_pk_fma_f32 v[228:229], v[228:229], v[20:21], v[20:21] op_sel:[0,1,0] op_sel_hi:[1,1,0]
    v_pk_fma_f32 v[230:231], v[230:231], v[20:21], v[20:21] op_sel:[0,1,0] op_sel_hi:[1,1,0]
    v_pk_mul_f32 v[224:225], v[40:41], v[224:225]
    v_pk_mul_f32 v[226:227], v[42:43], v[226:227]
    v_pk_mul_f32 v[228:229], v[44:45], v[228:229]
    v_pk_mul_f32 v[230:231], v[46:47], v[230:231]
    v_exp_f32 v224, v224
    v_exp_f32 v225, v225
    v_exp_f32 v226, v226
    v_exp_f32 v227, v227
    v_exp_f32 v228, v228
    v_exp_f32 v229, v229
    v_exp_f32 v230, v230
    v_exp_f32 v231, v231
    v_pk_fma_f32 v[224:225], v[224:225], v[28:29], v[28:29] op_sel_hi:[1,0,0]
    v_pk_fma_f32 v[226:227], v[226:227], v[28:29], v[28:29] op_sel_hi:[1,0,0]
    v_pk_fma_f32 v[228:229], v[228:229], v[28:29], v[28:29] op_sel_hi:[1,0,0]
    v_pk_fma_f32 v[230:231], v[230:231], v[28:29], v[28:29] op_sel_hi:[1,0,0]
    v_rcp_f32 v224, v224
    v_rcp_f32 v225, v225
    v_rcp_f32 v226, v226
    v_rcp_f32 v227, v227
    v_rcp_f32 v228, v228
    v_rcp_f32 v229, v229
    v_rcp_f32 v230, v230
    v_rcp_f32 v231, v231
    v_pk_mul_f32 v[224:225], v[40:41], v[224:225]
    v_pk_mul_f32 v[226:227], v[42:43], v[226:227]
    v_pk_mul_f32 v[228:229], v[44:45], v[228:229]
    v_pk_mul_f32 v[230:231], v[46:47], v[230:231]
    v_cvt_pk_bf16_f32 v240, v224, v225
    v_cvt_pk_bf16_f32 v241, v226, v227
    v_cvt_pk_bf16_f32 v242, v228, v229
    v_cvt_pk_bf16_f32 v243, v230, v231
    s_add_u32 s43, s51, 28672
    buffer_store_dwordx4 v[240:243], v11, s[20:23], s43 offen offset:0 sc1
    s_waitcnt vmcnt(1)
    s_mov_b64 exec, 1
    s_cmp_eq_u64 s[98:99], 0
    s_cbranch_scc0 L_s_8a
    buffer_store_dword v18, v17, s[20:23], s50 offen offset:0
L_s_8:
    s_mov_b64 exec, -1
    v_pk_mul_f32 v[224:225], v[56:57], v[56:57]
    v_pk_mul_f32 v[226:227], v[58:59], v[58:59]
    v_pk_mul_f32 v[228:229], v[60:61], v[60:61]
    v_pk_mul_f32 v[230:231], v[62:63], v[62:63]
    v_pk_fma_f32 v[224:225], v[224:225], v[22:23], v[22:23] op_sel:[0,1,0] op_sel_hi:[1,1,0]
    v_pk_fma_f32 v[226:227], v[226:227], v[22:23], v[22:23] op_sel:[0,1,0] op_sel_hi:[1,1,0]
    v_pk_fma_f32 v[228:229], v[228:229], v[22:23], v[22:23] op_sel:[0,1,0] op_sel_hi:[1,1,0]
    v_pk_fma_f32 v[230:231], v[230:231], v[22:23], v[22:23] op_sel:[0,1,0] op_sel_hi:[1,1,0]
    v_pk_mul_f32 v[224:225], v[56:57], v[224:225]
    v_pk_mul_f32 v[226:227], v[58:59], v[226:227]
    v_pk_mul_f32 v[228:229], v[60:61], v[228:229]
    v_pk_mul_f32 v[230:231], v[62:63], v[230:231]
    v_exp_f32 v224, v224
    v_exp_f32 v225, v225
    v_exp_f32 v226, v226
    v_exp_f32 v227, v227
    v_exp_f32 v228, v228
    v_exp_f32 v229, v229
    v_exp_f32 v230, v230
    v_exp_f32 v231, v231
    v_pk_fma_f32 v[224:225], v[224:225], v[28:29], v[28:29] op_sel:[0,1,1] op_sel_hi:[1,1,1]
    v_pk_fma_f32 v[226:227], v[226:227], v[28:29], v[28:29] op_sel:[0,1,1] op_sel_hi:[1,1,1]
    v_pk_fma_f32 v[228:229], v[228:229], v[28:29], v[28:29] op_sel:[0,1,1] op_sel_hi:[1,1,1]
    v_pk_fma_f32 v[230:231], v[230:231], v[28:29], v[28:29] op_sel:[0,1,1] op_sel_hi:[1,1,1]
    v_rcp_f32 v224, v224
    v_rcp_f32 v225, v225
    v_rcp_f32 v226, v226
    v_rcp_f32 v227, v227
    v_rcp_f32 v228, v228
    v_rcp_f32 v229, v229
    v_rcp_f32 v230, v230
    v_rcp_f32 v231, v231
    v_pk_mul_f32 v[224:225], v[56:57], v[224:225]
    v_pk_mul_f32 v[226:227], v[58:59], v[226:227]
    v_pk_mul_f32 v[228:229], v[60:61], v[228:229]
    v_pk_mul_f32 v[230:231], v[62:63], v[230:231]
    v_cvt_pk_bf16_f32 v244, v224, v225
    v_cvt_pk_bf16_f32 v245, v226, v227
    v_cvt_pk_bf16_f32 v246, v228, v229
    v_cvt_pk_bf16_f32 v247, v230, v231
    s_add_u32 s43, s51, 28672
    buffer_store_dwordx4 v[244:247], v11, s[20:23], s43 offen offset:1024 sc1
    v_pk_mul_f32 v[224:225], v[72:73], v[72:73]
    v_pk_mul_f32 v[226:227], v[74:75], v[74:75]
    v_pk_mul_f32 v[228:229], v[76:77], v[76:77]
    v_pk_mul_f32 v[230:231], v[78:79], v[78:79]
    v_pk_fma_f32 v[224:225], v[224:225], v[24:25], v[24:25] op_sel:[0,1,0] op_sel_hi:[1,1,0]
    v_pk_fma_f32 v[226:227], v[226:227], v[24:25], v[24:25] op_sel:[0,1,0] op_sel_hi:[1,1,0]
    v_pk_fma_f32 v[228:229], v[228:229], v[24:25], v[24:25] op_sel:[0,1,0] op_sel_hi:[1,1,0]
    v_pk_fma_f32 v[230:231], v[230:231], v[24:25], v[24:25] op_sel:[0,1,0] op_sel_hi:[1,1,0]
    v_pk_mul_f32 v[224:225], v[72:73], v[224:225]
    v_pk_mul_f32 v[226:227], v[74:75], v[226:227]
    v_pk_mul_f32 v[228:229], v[76:77], v[228:229]
    v_pk_mul_f32 v[230:231], v[78:79], v[230:231]
    v_exp_f32 v224, v224
    v_exp_f32 v225, v225
    v_exp_f32 v226, v226
    v_exp_f32 v227, v227
    v_exp_f32 v228, v228
    v_exp_f32 v229, v229
    v_exp_f32 v230, v230
    v_exp_f32 v231, v231
    v_pk_fma_f32 v[224:225], v[224:225], v[30:31], v[30:31] op_sel_hi:[1,0,0]
    v_pk_fma_f32 v[226:227], v[226:227], v[30:31], v[30:31] op_sel_hi:[1,0,0]
    v_pk_fma_f32 v[228:229], v[228:229], v[30:31], v[30:31] op_sel_hi:[1,0,0]
    v_pk_fma_f32 v[230:231], v[230:231], v[30:31], v[30:31] op_sel_hi:[1,0,0]
    v_rcp_f32 v224, v224
    v_rcp_f32 v225, v225
    v_rcp_f32 v226, v226
    v_rcp_f32 v227, v227
    v_rcp_f32 v228, v228
    v_rcp_f32 v229, v229
    v_rcp_f32 v230, v230
    v_rcp_f32 v231, v231
    v_pk_mul_f32 v[224:225], v[72:73], v[224:225]
    v_pk_mul_f32 v[226:227], v[74:75], v[226:227]
    v_pk_mul_f32 v[228:229], v[76:77], v[228:229]
    v_pk_mul_f32 v[230:231], v[78:79], v[230:231]
    v_cvt_pk_bf16_f32 v248, v224, v225
    v_cvt_pk_bf16_f32 v249, v226, v227
    v_cvt_pk_bf16_f32 v250, v228, v229
    v_cvt_pk_bf16_f32 v251, v230, v231
    s_add_u32 s43, s51, 143360
    buffer_store_dwordx4 v[248:251], v11, s[20:23], s43 offen offset:0 sc1
    v_pk_mul_f32 v[224:225], v[88:89], v[88:89]
    v_pk_mul_f32 v[226:227], v[90:91], v[90:91]
    v_pk_mul_f32 v[228:229], v[92:93], v[92:93]
    v_pk_mul_f32 v[230:231], v[94:95], v[94:95]
    v_pk_fma_f32 v[224:225], v[224:225], v[26:27], v[26:27] op_sel:[0,1,0] op_sel_hi:[1,1,0]
    v_pk_fma_f32 v[226:227], v[226:227], v[26:27], v[26:27] op_sel:[0,1,0] op_sel_hi:[1,1,0]
    v_pk_fma_f32 v[228:229], v[228:229], v[26:27], v[26:27] op_sel:[0,1,0] op_sel_hi:[1,1,0]
    v_pk_fma_f32 v[230:231], v[230:231], v[26:27], v[26:27] op_sel:[0,1,0] op_sel_hi:[1,1,0]
    v_pk_mul_f32 v[224:225], v[88:89], v[224:225]
    v_pk_mul_f32 v[226:227], v[90:91], v[226:227]
    v_pk_mul_f32 v[228:229], v[92:93], v[228:229]
    v_pk_mul_f32 v[230:231], v[94:95], v[230:231]
    v_exp_f32 v224, v224
    v_exp_f32 v225, v225
    v_exp_f32 v226, v226
    v_exp_f32 v227, v227
    v_exp_f32 v228, v228
    v_exp_f32 v229, v229
    v_exp_f32 v230, v230
    v_exp_f32 v231, v231
    v_pk_fma_f32 v[224:225], v[224:225], v[30:31], v[30:31] op_sel:[0,1,1] op_sel_hi:[1,1,1]
    v_pk_fma_f32 v[226:227], v[226:227], v[30:31], v[30:31] op_sel:[0,1,1] op_sel_hi:[1,1,1]
    v_pk_fma_f32 v[228:229], v[228:229], v[30:31], v[30:31] op_sel:[0,1,1] op_sel_hi:[1,1,1]
    v_pk_fma_f32 v[230:231], v[230:231], v[30:31], v[30:31] op_sel:[0,1,1] op_sel_hi:[1,1,1]
    v_rcp_f32 v224, v224
    v_rcp_f32 v225, v225
    v_rcp_f32 v226, v226
    v_rcp_f32 v227, v227
    v_rcp_f32 v228, v228
    v_rcp_f32 v229, v229
    v_rcp_f32 v230, v230
    v_rcp_f32 v231, v231
    v_pk_mul_f32 v[224:225], v[88:89], v[224:225]
    v_pk_mul_f32 v[226:227], v[90:91], v[226:227]
    v_pk_mul_f32 v[228:229], v[92:93], v[228:229]
    v_pk_mul_f32 v[230:231], v[94:95], v[230:231]
    v_cvt_pk_bf16_f32 v240, v224, v225
    v_cvt_pk_bf16_f32 v241, v226, v227
    v_cvt_pk_bf16_f32 v242, v228, v229
    v_cvt_pk_bf16_f32 v243, v230, v231
    s_add_u32 s43, s51, 143360
    buffer_store_dwordx4 v[240:243], v11, s[20:23], s43 offen offset:1024 sc1
L_c_p2:
    s_waitcnt lgkmcnt(0)
    s_barrier
    buffer_load_dwordx4 v[32:35], v11, s[20:23], s64 offen offset:0 sc1
    buffer_load_dwordx4 v[36:39], v11, s[20:23], s64 offen offset:1024 sc1
    buffer_load_dwordx4 v[48:51], v11, s[20:23], s64 offen offset:2048 sc1
    buffer_load_dwordx4 v[52:55], v11, s[20:23], s64 offen offset:3072 sc1
    buffer_load_dwordx4 v[64:67], v11, s[20:23], s65 offen offset:0 sc1
    buffer_load_dwordx4 v[68:71], v11, s[20:23], s65 offen offset:1024 sc1
    buffer_load_dwordx4 v[80:83], v11, s[20:23], s65 offen offset:2048 sc1
    buffer_load_dwordx4 v[84:87], v11, s[20:23], s65 offen offset:3072 sc1
    s_cmp_ge_u32 s5, 14
    s_cbranch_scc1 L_c_nfb
    s_waitcnt vmcnt(8)
    s_mov_b64 exec, 1
    s_cmp_eq_u64 s[98:99], 0
    s_cbranch_scc0 L_s_9a
    buffer_store_dword v18, v17, s[20:23], s50 offen offset:64
L_s_9:
    s_mov_b64 exec, -1
    v_lshlrev_b32 v20, 16, v2
    v_and_b32 v21, s55, v2
    v_lshlrev_b32 v22, 16, v3
    v_and_b32 v23, s55, v3
    v_lshlrev_b32 v24, 16, v4
    v_and_b32 v25, s55, v4
    v_lshlrev_b32 v26, 16, v5
    v_and_b32 v27, s55, v5
    v_lshrrev_b32 v29, 3, v0
    s_lshl_b32 s43, s3, 3
    v_add_u32 v29, s43, v29
    v_lshl_add_u32 v30, v29, 10, v6
    v_and_b32 v28, 7, v0
    v_lshlrev_b32 v28, 1, v28
    v_and_b32 v2, 15, v29
    v_xor_b32 v28, v28, v2
    v_lshlrev_b32 v28, 4, v28
    v_lshl_add_u32 v28, v29, 8, v28
    v_add_u32 v28, 49152, v28
    v_xor_b32 v29, 16, v28
    s_lshl_b32 s47, s4, 17
    s_lshl_b32 s44, s6, 16
    s_add_u32 s47, s47, s44
    s_lshl_b32 s44, s7, 7
    s_add_u32 s47, s47, s44
L_c_nfb:
    s_waitcnt vmcnt(7)
    v_mfma_f32_16x16x32_bf16 v[224:227], v[96:99], v[32:35], 0
    v_mfma_f32_16x16x32_bf16 v[228:231], v[100:103], v[32:35], 0
    buffer_load_dwordx4 v[40:43], v11, s[20:23], s66 offen offset:0 sc1
    v_mfma_f32_16x16x32_bf16 v[232:235], v[104:107], v[32:35], 0
    v_mfma_f32_16x16x32_bf16 v[236:239], v[108:111], v[32:35], 0
    s_waitcnt vmcnt(7)
    v_mfma_f32_16x16x32_bf16 v[240:243], v[96:99], v[36:39], 0
    buffer_load_dwordx4 v[44:47], v11, s[20:23], s66 offen offset:1024 sc1
    v_mfma_f32_16x16x32_bf16 v[244:247], v[100:103], v[36:39], 0
    v_mfma_f32_16x16x32_bf16 v[248:251], v[104:107], v[36:39], 0
    buffer_load_dwordx4 v[56:59], v11, s[20:23], s66 offen offset:2048 sc1
    v_mfma_f32_16x16x32_bf16 v[252:255], v[108:111], v[36:39], 0
    s_waitcnt vmcnt(8)
    v_mfma_f32_16x16x32_bf16 v[224:227], v[112:115], v[48:51], v[224:227]
    v_mfma_f32_16x16x32_bf16 v[228:231], v[116:119], v[48:51], v[228:231]
    buffer_load_dwordx4 v[60:63], v11, s[20:23], s66 offen offset:3072 sc1
    v_mfma_f32_16x16x32_bf16 v[232:235], v[120:123], v[48:51], v[232:235]
    v_mfma_f32_16x16x32_bf16 v[236:239], v[124:127], v[48:51], v[236:239]
    s_waitcnt vmcnt(8)
    v_mfma_f32_16x16x32_bf16 v[240:243], v[112:115], v[52:55], v[240:243]
    buffer_load_dwordx4 v[72:75], v11, s[20:23], s67 offen offset:0 sc1
    v_mfma_f32_16x16x32_bf16 v[244:247], v[116:119], v[52:55], v[244:247]
    v_mfma_f32_16x16x32_bf16 v[248:251], v[120:123], v[52:55], v[248:251]
    buffer_load_dwordx4 v[76:79], v11, s[20:23], s67 offen offset:1024 sc1
    v_mfma_f32_16x16x32_bf16 v[252:255], v[124:127], v[52:55], v[252:255]
    s_waitcnt vmcnt(9)
    v_mfma_f32_16x16x32_bf16 v[224:227], v[128:131], v[64:67], v[224:227]
    v_mfma_f32_16x16x32_bf16 v[228:231], v[132:135], v[64:67], v[228:231]
    buffer_load_dwordx4 v[88:91], v11, s[20:23], s67 offen offset:2048 sc1
    v_mfma_f32_16x16x32_bf16 v[232:235], v[136:139], v[64:67], v[232:235]
    v_mfma_f32_16x16x32_bf16 v[236:239], v[140:143], v[64:67], v[236:239]
    s_waitcnt vmcnt(9)
    v_mfma_f32_16x16x32_bf16 v[240:243], v[128:131], v[68:71], v[240:243]
    buffer_load_dwordx4 v[92:95], v11, s[20:23], s67 offen offset:3072 sc1
    v_mfma_f32_16x16x32_bf16 v[244:247], v[132:135], v[68:71], v[244:247]
    v_mfma_f32_16x16x32_bf16 v[248:251], v[136:139], v[68:71], v[248:251]
    buffer_load_dwordx4 v[32:35], v11, s[20:23], s68 offen offset:0 sc1
    v_mfma_f32_16x16x32_bf16 v[252:255], v[140:143], v[68:71], v[252:255]
    s_waitcnt vmcnt(10)
    v_mfma_f32_16x16x32_bf16 v[224:227], v[144:147], v[80:83], v[224:227]
    v_mfma_f32_16x16x32_bf16 v[228:231], v[148:151], v[80:83], v[228:231]
    buffer_load_dwordx4 v[36:39], v11, s[20:23], s68 offen offset:1024 sc1
    v_mfma_f32_16x16x32_bf16 v[232:235], v[152:155], v[80:83], v[232:235]
    v_mfma_f32_16x16x32_bf16 v[236:239], v[156:159], v[80:83], v[236:239]
    s_waitcnt vmcnt(10)
    v_mfma_f32_16x16x32_bf16 v[240:243], v[144:147], v[84:87], v[240:243]
    buffer_load_dwordx4 v[48:51], v11, s[20:23], s68 offen offset:2048 sc1
    v_mfma_f32_16x16x32_bf16 v[244:247], v[148:151], v[84:87], v[244:247]
    v_mfma_f32_16x16x32_bf16 v[248:251], v[152:155], v[84:87], v[248:251]
    buffer_load_dwordx4 v[52:55], v11, s[20:23], s68 offen offset:3072 sc1
    v_mfma_f32_16x16x32_bf16 v[252:255], v[156:159], v[84:87], v[252:255]
    s_waitcnt vmcnt(11)
    v_mfma_f32_16x16x32_bf16 v[224:227], v[160:163], v[40:43], v[224:227]
    ds_read_b64_tr_b16 v[96:97], v8 offset:49152
    v_mfma_f32_16x16x32_bf16 v[228:231], v[164:167], v[40:43], v[228:231]
    ds_read_b64_tr_b16 v[98:99], v8 offset:51200
    buffer_load_dwordx4 v[64:67], v11, s[20:23], s69 offen offset:0 sc1
    v_mfma_f32_16x16x32_bf16 v[232:235], v[168:171], v[40:43], v[232:235]
    ds_read_b64_tr_b16 v[100:101], v9 offset:49152
    v_mfma_f32_16x16x32_bf16 v[236:239], v[172:175], v[40:43], v[236:239]
    ds_read_b64_tr_b16 v[102:103], v9 offset:51200
    s_waitcnt vmcnt(11)
    v_mfma_f32_16x16x32_bf16 v[240:243], v[160:163], v[44:47], v[240:243]
    ds_read_b64_tr_b16 v[104:105], v10 offset:49152
    buffer_load_dwordx4 v[68:71], v11, s[20:23], s69 offen offset:1024 sc1
    v_mfma_f32_16x16x32_bf16 v[244:247], v[164:167], v[44:47], v[244:247]
    ds_read_b64_tr_b16 v[106:107], v10 offset:51200
    v_mfma_f32_16x16x32_bf16 v[248:251], v[168:171], v[44:47], v[248:251]
    ds_read_b64_tr_b16 v[108:109], v19 offset:49152
    buffer_load_dwordx4 v[80:83], v11, s[20:23], s69 offen offset:2048 sc1
    v_mfma_f32_16x16x32_bf16 v[252:255], v[172:175], v[44:47], v[252:255]
    ds_read_b64_tr_b16 v[110:111], v19 offset:51200
    s_waitcnt vmcnt(12)
    v_mfma_f32_16x16x32_bf16 v[224:227], v[176:179], v[56:59], v[224:227]
    v_add_u32 v8, 0xe000, v8
    v_add_u32 v9, 0xe000, v9
    v_mfma_f32_16x16x32_bf16 v[228:231], v[180:183], v[56:59], v[228:231]
    v_add_u32 v10, 0xe000, v10
    buffer_load_dwordx4 v[84:87], v11, s[20:23], s69 offen offset:3072 sc1
    v_mfma_f32_16x16x32_bf16 v[232:235], v[184:187], v[56:59], v[232:235]
    v_add_u32 v19, 0xe000, v19
    ds_read_b64_tr_b16 v[112:113], v8 offset:0
    v_mfma_f32_16x16x32_bf16 v[236:239], v[188:191], v[56:59], v[236:239]
    ds_read_b64_tr_b16 v[114:115], v8 offset:2048
    s_waitcnt vmcnt(12)
    v_mfma_f32_16x16x32_bf16 v[240:243], v[176:179], v[60:63], v[240:243]
    ds_read_b64_tr_b16 v[116:117], v9 offset:0
    ds_read_b64_tr_b16 v[118:119], v9 offset:2048
    v_mfma_f32_16x16x32_bf16 v[244:247], v[180:183], v[60:63], v[244:247]
    ds_read_b64_tr_b16 v[120:121], v10 offset:0
    v_mfma_f32_16x16x32_bf16 v[248:251], v[184:187], v[60:63], v[248:251]
    ds_read_b64_tr_b16 v[122:123], v10 offset:2048
    ds_read_b64_tr_b16 v[124:125], v19 offset:0
    buffer_load_dwordx4 v[40:43], v11, s[20:23], s70 offen offset:0 sc1
    v_mfma_f32_16x16x32_bf16 v[252:255], v[188:191], v[60:63], v[252:255]
    ds_read_b64_tr_b16 v[126:127], v19 offset:2048
    s_waitcnt vmcnt(12)
    v_mfma_f32_16x16x32_bf16 v[224:227], v[192:195], v[72:75], v[224:227]
    ds_read_b64_tr_b16 v[128:129], v8 offset:8192
    v_mfma_f32_16x16x32_bf16 v[228:231], v[196:199], v[72:75], v[228:231]
    ds_read_b64_tr_b16 v[130:131], v8 offset:10240
    buffer_load_dwordx4 v[44:47], v11, s[20:23], s70 offen offset:1024 sc1
    v_mfma_f32_16x16x32_bf16 v[232:235], v[200:203], v[72:75], v[232:235]
    ds_read_b64_tr_b16 v[132:133], v9 offset:8192
    v_mfma_f32_16x16x32_bf16 v[236:239], v[204:207], v[72:75], v[236:239]
    ds_read_b64_tr_b16 v[134:135], v9 offset:10240
    s_waitcnt vmcnt(12)
    v_mfma_f32_16x16x32_bf16 v[240:243], v[192:195], v[76:79], v[240:243]
    ds_read_b64_tr_b16 v[136:137], v10 offset:8192
    v_mfma_f32_16x16x32_bf16 v[244:247], v[196:199], v[76:79], v[244:247]
    ds_read_b64_tr_b16 v[138:139], v10 offset:10240
    v_mfma_f32_16x16x32_bf16 v[248:251], v[200:203], v[76:79], v[248:251]
    ds_read_b64_tr_b16 v[140:141], v19 offset:8192
    buffer_load_dwordx4 v[56:59], v11, s[20:23], s70 offen offset:2048 sc1
    v_mfma_f32_16x16x32_bf16 v[252:255], v[204:207], v[76:79], v[252:255]
    ds_read_b64_tr_b16 v[142:143], v19 offset:10240
    s_waitcnt vmcnt(12)
    v_mfma_f32_16x16x32_bf16 v[224:227], v[208:211], v[88:91], v[224:227]
    ds_read_b64_tr_b16 v[144:145], v8 offset:16384
    v_mfma_f32_16x16x32_bf16 v[228:231], v[212:215], v[88:91], v[228:231]
    ds_read_b64_tr_b16 v[146:147], v8 offset:18432
    buffer_load_dwordx4 v[60:63], v11, s[20:23], s70 offen offset:3072 sc1
    v_mfma_f32_16x16x32_bf16 v[232:235], v[216:219], v[88:91], v[232:235]
    ds_read_b64_tr_b16 v[148:149], v9 offset:16384
    v_mfma_f32_16x16x32_bf16 v[236:239], v[220:223], v[88:91], v[236:239]
    ds_read_b64_tr_b16 v[150:151], v9 offset:18432
    s_waitcnt vmcnt(12)
    v_mfma_f32_16x16x32_bf16 v[240:243], v[208:211], v[92:95], v[240:243]
    ds_read_b64_tr_b16 v[152:153], v10 offset:16384
    v_mfma_f32_16x16x32_bf16 v[244:247], v[212:215], v[92:95], v[244:247]
    ds_read_b64_tr_b16 v[154:155], v10 offset:18432
    v_mfma_f32_16x16x32_bf16 v[248:251], v[216:219], v[92:95], v[248:251]
    ds_read_b64_tr_b16 v[156:157], v19 offset:16384
    v_mfma_f32_16x16x32_bf16 v[252:255], v[220:223], v[92:95], v[252:255]
    ds_read_b64_tr_b16 v[158:159], v19 offset:18432
    s_waitcnt vmcnt(11) lgkmcnt(14)
    v_mfma_f32_16x16x32_bf16 v[224:227], v[96:99], v[32:35], v[224:227]
    ds_read_b64_tr_b16 v[160:161], v8 offset:24576
    v_mfma_f32_16x16x32_bf16 v[228:231], v[100:103], v[32:35], v[228:231]
    ds_read_b64_tr_b16 v[162:163], v8 offset:26624
    v_mfma_f32_16x16x32_bf16 v[232:235], v[104:107], v[32:35], v[232:235]
    ds_read_b64_tr_b16 v[164:165], v9 offset:24576
    v_mfma_f32_16x16x32_bf16 v[236:239], v[108:111], v[32:35], v[236:239]
    ds_read_b64_tr_b16 v[166:167], v9 offset:26624
    s_waitcnt vmcnt(10)
    v_mfma_f32_16x16x32_bf16 v[240:243], v[96:99], v[36:39], v[240:243]
    ds_read_b64_tr_b16 v[168:169], v10 offset:24576
    v_mfma_f32_16x16x32_bf16 v[244:247], v[100:103], v[36:39], v[244:247]
    ds_read_b64_tr_b16 v[170:171], v10 offset:26624
    v_mfma_f32_16x16x32_bf16 v[248:251], v[104:107], v[36:39], v[248:251]
    ds_read_b64_tr_b16 v[172:173], v19 offset:24576
    v_mfma_f32_16x16x32_bf16 v[252:255], v[108:111], v[36:39], v[252:255]
    ds_read_b64_tr_b16 v[174:175], v19 offset:26624
    s_waitcnt vmcnt(9)
    v_mfma_f32_16x16x32_bf16 v[224:227], v[112:115], v[48:51], v[224:227]
    ds_read_b64_tr_b16 v[176:177], v8 offset:32768
    v_mfma_f32_16x16x32_bf16 v[228:231], v[116:119], v[48:51], v[228:231]
    ds_read_b64_tr_b16 v[178:179], v8 offset:34816
    v_mfma_f32_16x16x32_bf16 v[232:235], v[120:123], v[48:51], v[232:235]
    ds_read_b64_tr_b16 v[180:181], v9 offset:32768
    v_mfma_f32_16x16x32_bf16 v[236:239], v[124:127], v[48:51], v[236:239]
    ds_read_b64_tr_b16 v[182:183], v9 offset:34816
    s_waitcnt vmcnt(8)
    v_mfma_f32_16x16x32_bf16 v[240:243], v[112:115], v[52:55], v[240:243]
    ds_read_b64_tr_b16 v[184:185], v10 offset:32768
    v_mfma_f32_16x16x32_bf16 v[244:247], v[116:119], v[52:55], v[244:247]
    ds_read_b64_tr_b16 v[186:187], v10 offset:34816
    v_mfma_f32_16x16x32_bf16 v[248:251], v[120:123], v[52:55], v[248:251]
    ds_read_b64_tr_b16 v[188:189], v19 offset:32768
    v_mfma_f32_16x16x32_bf16 v[252:255], v[124:127], v[52:55], v[252:255]
    ds_read_b64_tr_b16 v[190:191], v19 offset:34816
    s_waitcnt lgkmcnt(0)
    s_barrier
    s_add_u32 s64, s64, 28672
    buffer_load_dwordx4 v[72:75], v11, s[20:23], s64 offen offset:0 sc1
    buffer_load_dwordx4 v[76:79], v11, s[20:23], s64 offen offset:1024 sc1
    s_waitcnt vmcnt(9)
    v_mfma_f32_16x16x32_bf16 v[224:227], v[128:131], v[64:67], v[224:227]
    ds_read_b64_tr_b16 v[192:193], v8 offset:40960
    v_mfma_f32_16x16x32_bf16 v[228:231], v[132:135], v[64:67], v[228:231]
    ds_read_b64_tr_b16 v[194:195], v8 offset:43008
    buffer_load_dwordx4 v[88:91], v11, s[20:23], s64 offen offset:2048 sc1
    v_mfma_f32_16x16x32_bf16 v[232:235], v[136:139], v[64:67], v[232:235]
    ds_read_b64_tr_b16 v[196:197], v9 offset:40960
    v_mfma_f32_16x16x32_bf16 v[236:239], v[140:143], v[64:67], v[236:239]
    ds_read_b64_tr_b16 v[198:199], v9 offset:43008
    s_waitcnt vmcnt(9)
    v_mfma_f32_16x16x32_bf16 v[240:243], v[128:131], v[68:71], v[240:243]
    ds_read_b64_tr_b16 v[200:201], v10 offset:40960
    buffer_load_dwordx4 v[92:95], v11, s[20:23], s64 offen offset:3072 sc1
    v_mfma_f32_16x16x32_bf16 v[244:247], v[132:135], v[68:71], v[244:247]
    ds_read_b64_tr_b16 v[202:203], v10 offset:43008
    v_mfma_f32_16x16x32_bf16 v[248:251], v[136:139], v[68:71], v[248:251]
    ds_read_b64_tr_b16 v[204:205], v19 offset:40960
    s_add_u32 s65, s65, 28672
    buffer_load_dwordx4 v[32:35], v11, s[20:23], s65 offen offset:0 sc1
    v_mfma_f32_16x16x32_bf16 v[252:255], v[140:143], v[68:71], v[252:255]
    ds_read_b64_tr_b16 v[206:207], v19 offset:43008
    s_waitcnt vmcnt(10)
    v_mfma_f32_16x16x32_bf16 v[224:227], v[144:147], v[80:83], v[224:227]
    ds_read_b64_tr_b16 v[208:209], v8 offset:49152
    v_mfma_f32_16x16x32_bf16 v[228:231], v[148:151], v[80:83], v[228:231]
    ds_read_b64_tr_b16 v[210:211], v8 offset:51200
    buffer_load_dwordx4 v[36:39], v11, s[20:23], s65 offen offset:1024 sc1
    v_mfma_f32_16x16x32_bf16 v[232:235], v[152:155], v[80:83], v[232:235]
    ds_read_b64_tr_b16 v[212:213], v9 offset:49152
    v_mfma_f32_16x16x32_bf16 v[236:239], v[156:159], v[80:83], v[236:239]
    ds_read_b64_tr_b16 v[214:215], v9 offset:51200
    s_waitcnt vmcnt(10)
    v_mfma_f32_16x16x32_bf16 v[240:243], v[144:147], v[84:87], v[240:243]
    ds_read_b64_tr_b16 v[216:217], v10 offset:49152
    buffer_load_dwordx4 v[48:51], v11, s[20:23], s65 offen offset:2048 sc1
    v_mfma_f32_16x16x32_bf16 v[244:247], v[148:151], v[84:87], v[244:247]
    ds_read_b64_tr_b16 v[218:219], v10 offset:51200
    v_mfma_f32_16x16x32_bf16 v[248:251], v[152:155], v[84:87], v[248:251]
    ds_read_b64_tr_b16 v[220:221], v19 offset:49152
    buffer_load_dwordx4 v[52:55], v11, s[20:23], s65 offen offset:3072 sc1
    v_mfma_f32_16x16x32_bf16 v[252:255], v[156:159], v[84:87], v[252:255]
    ds_read_b64_tr_b16 v[222:223], v19 offset:51200
    s_waitcnt vmcnt(11)
    v_mfma_f32_16x16x32_bf16 v[224:227], v[160:163], v[40:43], v[224:227]
    v_add_u32 v8, 0xe000, v8
    v_add_u32 v9, 0xe000, v9
    v_mfma_f32_16x16x32_bf16 v[228:231], v[164:167], v[40:43], v[228:231]
    v_add_u32 v10, 0xe000, v10
    s_add_u32 s66, s66, 28672
    buffer_load_dwordx4 v[64:67], v11, s[20:23], s66 offen offset:0 sc1
    v_mfma_f32_16x16x32_bf16 v[232:235], v[168:171], v[40:43], v[232:235]
    v_add_u32 v19, 0xe000, v19
    ds_read_b64_tr_b16 v[96:97], v8 offset:0
    v_mfma_f32_16x16x32_bf16 v[236:239], v[172:175], v[40:43], v[236:239]
    ds_read_b64_tr_b16 v[98:99], v8 offset:2048
    s_waitcnt vmcnt(11)
    v_mfma_f32_16x16x32_bf16 v[240:243], v[160:163], v[44:47], v[240:243]
    ds_read_b64_tr_b16 v[100:101], v9 offset:0
    ds_read_b64_tr_b16 v[102:103], v9 offset:2048
    buffer_load_dwordx4 v[68:71], v11, s[20:23], s66 offen offset:1024 sc1
    v_mfma_f32_16x16x32_bf16 v[244:247], v[164:167], v[44:47], v[244:247]
    ds_read_b64_tr_b16 v[104:105], v10 offset:0
    v_mfma_f32_16x16x32_bf16 v[248:251], v[168:171], v[44:47], v[248:251]
    ds_read_b64_tr_b16 v[106:107], v10 offset:2048
    ds_read_b64_tr_b16 v[108:109], v19 offset:0
    buffer_load_dwordx4 v[80:83], v11, s[20:23], s66 offen offset:2048 sc1
    v_mfma_f32_16x16x32_bf16 v[252:255], v[172:175], v[44:47], v[252:255]
    ds_read_b64_tr_b16 v[110:111], v19 offset:2048
    s_waitcnt vmcnt(12)
    v_mfma_f32_16x16x32_bf16 v[224:227], v[176:179], v[56:59], v[224:227]
    ds_read_b64_tr_b16 v[112:113], v8 offset:8192
    v_mfma_f32_16x16x32_bf16 v[228:231], v[180:183], v[56:59], v[228:231]
    ds_read_b64_tr_b16 v[114:115], v8 offset:10240
    buffer_load_dwordx4 v[84:87], v11, s[20:23], s66 offen offset:3072 sc1
    v_mfma_f32_16x16x32_bf16 v[232:235], v[184:187], v[56:59], v[232:235]
    ds_read_b64_tr_b16 v[116:117], v9 offset:8192
    v_mfma_f32_16x16x32_bf16 v[236:239], v[188:191], v[56:59], v[236:239]
    ds_read_b64_tr_b16 v[118:119], v9 offset:10240
    s_waitcnt vmcnt(12)
    v_mfma_f32_16x16x32_bf16 v[240:243], v[176:179], v[60:63], v[240:243]
    ds_read_b64_tr_b16 v[120:121], v10 offset:8192
    v_mfma_f32_16x16x32_bf16 v[244:247], v[180:183], v[60:63], v[244:247]
    ds_read_b64_tr_b16 v[122:123], v10 offset:10240
    v_mfma_f32_16x16x32_bf16 v[248:251], v[184:187], v[60:63], v[248:251]
    ds_read_b64_tr_b16 v[124:125], v19 offset:8192
    s_add_u32 s67, s67, 28672
    buffer_load_dwordx4 v[40:43], v11, s[20:23], s67 offen offset:0 sc1
    v_mfma_f32_16x16x32_bf16 v[252:255], v[188:191], v[60:63], v[252:255]
    ds_read_b64_tr_b16 v[126:127], v19 offset:10240
    s_waitcnt vmcnt(12) lgkmcnt(14)
    v_mfma_f32_16x16x32_bf16 v[224:227], v[192:195], v[72:75], v[224:227]
    ds_read_b64_tr_b16 v[128:129], v8 offset:16384
    v_mfma_f32_16x16x32_bf16 v[228:231], v[196:199], v[72:75], v[228:231]
    ds_read_b64_tr_b16 v[130:131], v8 offset:18432
    buffer_load_dwordx4 v[44:47], v11, s[20:23], s67 offen offset:1024 sc1
    v_mfma_f32_16x16x32_bf16 v[232:235], v[200:203], v[72:75], v[232:235]
    ds_read_b64_tr_b16 v[132:133], v9 offset:16384
    v_mfma_f32_16x16x32_bf16 v[236:239], v[204:207], v[72:75], v[236:239]
    ds_read_b64_tr_b16 v[134:135], v9 offset:18432
    s_waitcnt vmcnt(12)
    v_mfma_f32_16x16x32_bf16 v[240:243], v[192:195], v[76:79], v[240:243]
    ds_read_b64_tr_b16 v[136:137], v10 offset:16384
    v_mfma_f32_16x16x32_bf16 v[244:247], v[196:199], v[76:79], v[244:247]
    ds_read_b64_tr_b16 v[138:139], v10 offset:18432
    v_mfma_f32_16x16x32_bf16 v[248:251], v[200:203], v[76:79], v[248:251]
    ds_read_b64_tr_b16 v[140:141], v19 offset:16384
    buffer_load_dwordx4 v[56:59], v11, s[20:23], s67 offen offset:2048 sc1
    v_mfma_f32_16x16x32_bf16 v[252:255], v[204:207], v[76:79], v[252:255]
    ds_read_b64_tr_b16 v[142:143], v19 offset:18432
    s_waitcnt vmcnt(12)
    v_mfma_f32_16x16x32_bf16 v[224:227], v[208:211], v[88:91], v[224:227]
    ds_read_b64_tr_b16 v[144:145], v8 offset:24576
    v_mfma_f32_16x16x32_bf16 v[228:231], v[212:215], v[88:91], v[228:231]
    ds_read_b64_tr_b16 v[146:147], v8 offset:26624
    buffer_load_dwordx4 v[60:63], v11, s[20:23], s67 offen offset:3072 sc1
    v_mfma_f32_16x16x32_bf16 v[232:235], v[216:219], v[88:91], v[232:235]
    ds_read_b64_tr_b16 v[148:149], v9 offset:24576
    v_mfma_f32_16x16x32_bf16 v[236:239], v[220:223], v[88:91], v[236:239]
    ds_read_b64_tr_b16 v[150:151], v9 offset:26624
    s_waitcnt vmcnt(12)
    v_mfma_f32_16x16x32_bf16 v[240:243], v[208:211], v[92:95], v[240:243]
    ds_read_b64_tr_b16 v[152:153], v10 offset:24576
    v_mfma_f32_16x16x32_bf16 v[244:247], v[212:215], v[92:95], v[244:247]
    ds_read_b64_tr_b16 v[154:155], v10 offset:26624
    v_mfma_f32_16x16x32_bf16 v[248:251], v[216:219], v[92:95], v[248:251]
    ds_read_b64_tr_b16 v[156:157], v19 offset:24576
    s_add_u32 s68, s68, 28672
    buffer_load_dwordx4 v[72:75], v11, s[20:23], s68 offen offset:0 sc1
    v_mfma_f32_16x16x32_bf16 v[252:255], v[220:223], v[92:95], v[252:255]
    ds_read_b64_tr_b16 v[158:159], v19 offset:26624
    s_waitcnt vmcnt(12) lgkmcnt(14)
    v_mfma_f32_16x16x32_bf16 v[224:227], v[96:99], v[32:35], v[224:227]
    v_add_u32 v8, 0xfffe4000, v8
    v_add_u32 v9, 0xfffe4000, v9
    v_mfma_f32_16x16x32_bf16 v[228:231], v[100:103], v[32:35], v[228:231]
    v_add_u32 v10, 0xfffe4000, v10
    buffer_load_dwordx4 v[76:79], v11, s[20:23], s68 offen offset:1024 sc1
    v_mfma_f32_16x16x32_bf16 v[232:235], v[104:107], v[32:35], v[232:235]
    v_add_u32 v19, 0xfffe4000, v19
    ds_read_b64_tr_b16 v[160:161], v8 offset:0
    v_mfma_f32_16x16x32_bf16 v[236:239], v[108:111], v[32:35], v[236:239]
    ds_read_b64_tr_b16 v[162:163], v8 offset:2048
    s_waitcnt vmcnt(12)
    v_mfma_f32_16x16x32_bf16 v[240:243], v[96:99], v[36:39], v[240:243]
    ds_read_b64_tr_b16 v[164:165], v9 offset:0
    ds_read_b64_tr_b16 v[166:167], v9 offset:2048
    v_mfma_f32_16x16x32_bf16 v[244:247], v[100:103], v[36:39], v[244:247]
    ds_read_b64_tr_b16 v[168:169], v10 offset:0
    v_mfma_f32_16x16x32_bf16 v[248:251], v[104:107], v[36:39], v[248:251]
    ds_read_b64_tr_b16 v[170:171], v10 offset:2048
    ds_read_b64_tr_b16 v[172:173], v19 offset:0
    buffer_load_dwordx4 v[88:91], v11, s[20:23], s68 offen offset:2048 sc1
    v_mfma_f32_16x16x32_bf16 v[252:255], v[108:111], v[36:39], v[252:255]
    ds_read_b64_tr_b16 v[174:175], v19 offset:2048
    s_waitcnt vmcnt(12)
    v_mfma_f32_16x16x32_bf16 v[224:227], v[112:115], v[48:51], v[224:227]
    ds_read_b64_tr_b16 v[176:177], v8 offset:8192
    v_mfma_f32_16x16x32_bf16 v[228:231], v[116:119], v[48:51], v[228:231]
    ds_read_b64_tr_b16 v[178:179], v8 offset:10240
    buffer_load_dwordx4 v[92:95], v11, s[20:23], s68 offen offset:3072 sc1
    v_mfma_f32_16x16x32_bf16 v[232:235], v[120:123], v[48:51], v[232:235]
    ds_read_b64_tr_b16 v[180:181], v9 offset:8192
    v_mfma_f32_16x16x32_bf16 v[236:239], v[124:127], v[48:51], v[236:239]
    ds_read_b64_tr_b16 v[182:183], v9 offset:10240
    s_waitcnt vmcnt(12)
    v_mfma_f32_16x16x32_bf16 v[240:243], v[112:115], v[52:55], v[240:243]
    ds_read_b64_tr_b16 v[184:185], v10 offset:8192
    v_mfma_f32_16x16x32_bf16 v[244:247], v[116:119], v[52:55], v[244:247]
    ds_read_b64_tr_b16 v[186:187], v10 offset:10240
    v_mfma_f32_16x16x32_bf16 v[248:251], v[120:123], v[52:55], v[248:251]
    ds_read_b64_tr_b16 v[188:189], v19 offset:8192
    s_add_u32 s69, s69, 28672
    buffer_load_dwordx4 v[32:35], v11, s[20:23], s69 offen offset:0 sc1
    v_mfma_f32_16x16x32_bf16 v[252:255], v[124:127], v[52:55], v[252:255]
    ds_read_b64_tr_b16 v[190:191], v19 offset:10240
    s_waitcnt vmcnt(12) lgkmcnt(14)
    v_mfma_f32_16x16x32_bf16 v[224:227], v[128:131], v[64:67], v[224:227]
    ds_read_b64_tr_b16 v[192:193], v8 offset:16384
    v_mfma_f32_16x16x32_bf16 v[228:231], v[132:135], v[64:67], v[228:231]
    ds_read_b64_tr_b16 v[194:195], v8 offset:18432
    buffer_load_dwordx4 v[36:39], v11, s[20:23], s69 offen offset:1024 sc1
    v_mfma_f32_16x16x32_bf16 v[232:235], v[136:139], v[64:67], v[232:235]
    ds_read_b64_tr_b16 v[196:197], v9 offset:16384
    v_mfma_f32_16x16x32_bf16 v[236:239], v[140:143], v[64:67], v[236:239]
    ds_read_b64_tr_b16 v[198:199], v9 offset:18432
    s_waitcnt vmcnt(12)
    v_mfma_f32_16x16x32_bf16 v[240:243], v[128:131], v[68:71], v[240:243]
    ds_read_b64_tr_b16 v[200:201], v10 offset:16384
    v_mfma_f32_16x16x32_bf16 v[244:247], v[132:135], v[68:71], v[244:247]
    ds_read_b64_tr_b16 v[202:203], v10 offset:18432
    v_mfma_f32_16x16x32_bf16 v[248:251], v[136:139], v[68:71], v[248:251]
    ds_read_b64_tr_b16 v[204:205], v19 offset:16384
    buffer_load_dwordx4 v[48:51], v11, s[20:23], s69 offen offset:2048 sc1
    v_mfma_f32_16x16x32_bf16 v[252:255], v[140:143], v[68:71], v[252:255]
    ds_read_b64_tr_b16 v[206:207], v19 offset:18432
    s_waitcnt vmcnt(12)
    v_mfma_f32_16x16x32_bf16 v[224:227], v[144:147], v[80:83], v[224:227]
    ds_read_b64_tr_b16 v[208:209], v8 offset:24576
    v_mfma_f32_16x16x32_bf16 v[228:231], v[148:151], v[80:83], v[228:231]
    ds_read_b64_tr_b16 v[210:211], v8 offset:26624
    buffer_load_dwordx4 v[52:55], v11, s[20:23], s69 offen offset:3072 sc1
    v_mfma_f32_16x16x32_bf16 v[232:235], v[152:155], v[80:83], v[232:235]
    ds_read_b64_tr_b16 v[212:213], v9 offset:24576
    v_mfma_f32_16x16x32_bf16 v[236:239], v[156:159], v[80:83], v[236:239]
    ds_read_b64_tr_b16 v[214:215], v9 offset:26624
    s_waitcnt vmcnt(12)
    v_mfma_f32_16x16x32_bf16 v[240:243], v[144:147], v[84:87], v[240:243]
    ds_read_b64_tr_b16 v[216:217], v10 offset:24576
    v_mfma_f32_16x16x32_bf16 v[244:247], v[148:151], v[84:87], v[244:247]
    ds_read_b64_tr_b16 v[218:219], v10 offset:26624
    v_mfma_f32_16x16x32_bf16 v[248:251], v[152:155], v[84:87], v[248:251]
    ds_read_b64_tr_b16 v[220:221], v19 offset:24576
    s_add_u32 s70, s70, 28672
    buffer_load_dwordx4 v[64:67], v11, s[20:23], s70 offen offset:0 sc1
    v_mfma_f32_16x16x32_bf16 v[252:255], v[156:159], v[84:87], v[252:255]
    ds_read_b64_tr_b16 v[222:223], v19 offset:26624
    s_waitcnt vmcnt(12) lgkmcnt(14)
    v_mfma_f32_16x16x32_bf16 v[224:227], v[160:163], v[40:43], v[224:227]
    ds_read_b64_tr_b16 v[96:97], v8 offset:32768
    v_mfma_f32_16x16x32_bf16 v[228:231], v[164:167], v[40:43], v[228:231]
    ds_read_b64_tr_b16 v[98:99], v8 offset:34816
    buffer_load_dwordx4 v[68:71], v11, s[20:23], s70 offen offset:1024 sc1
    v_mfma_f32_16x16x32_bf16 v[232:235], v[168:171], v[40:43], v[232:235]
    ds_read_b64_tr_b16 v[100:101], v9 offset:32768
    v_mfma_f32_16x16x32_bf16 v[236:239], v[172:175], v[40:43], v[236:239]
    ds_read_b64_tr_b16 v[102:103], v9 offset:34816
    s_waitcnt vmcnt(12)
    v_mfma_f32_16x16x32_bf16 v[240:243], v[160:163], v[44:47], v[240:243]
    ds_read_b64_tr_b16 v[104:105], v10 offset:32768
    v_mfma_f32_16x16x32_bf16 v[244:247], v[164:167], v[44:47], v[244:247]
    ds_read_b64_tr_b16 v[106:107], v10 offset:34816
    v_mfma_f32_16x16x32_bf16 v[248:251], v[168:171], v[44:47], v[248:251]
    ds_read_b64_tr_b16 v[108:109], v19 offset:32768
    buffer_load_dwordx4 v[80:83], v11, s[20:23], s70 offen offset:2048 sc1
    v_mfma_f32_16x16x32_bf16 v[252:255], v[172:175], v[44:47], v[252:255]
    ds_read_b64_tr_b16 v[110:111], v19 offset:34816
    s_waitcnt vmcnt(12)
    v_mfma_f32_16x16x32_bf16 v[224:227], v[176:179], v[56:59], v[224:227]
    ds_read_b64_tr_b16 v[112:113], v8 offset:40960
    v_mfma_f32_16x16x32_bf16 v[228:231], v[180:183], v[56:59], v[228:231]
    ds_read_b64_tr_b16 v[114:115], v8 offset:43008
    buffer_load_dwordx4 v[84:87], v11, s[20:23], s70 offen offset:3072 sc1
    v_mfma_f32_16x16x32_bf16 v[232:235], v[184:187], v[56:59], v[232:235]
    ds_read_b64_tr_b16 v[116:117], v9 offset:40960
    v_mfma_f32_16x16x32_bf16 v[236:239], v[188:191], v[56:59], v[236:239]
    ds_read_b64_tr_b16 v[118:119], v9 offset:43008
    s_waitcnt vmcnt(12)
    v_mfma_f32_16x16x32_bf16 v[240:243], v[176:179], v[60:63], v[240:243]
    ds_read_b64_tr_b16 v[120:121], v10 offset:40960
    v_mfma_f32_16x16x32_bf16 v[244:247], v[180:183], v[60:63], v[244:247]
    ds_read_b64_tr_b16 v[122:123], v10 offset:43008
    v_mfma_f32_16x16x32_bf16 v[248:251], v[184:187], v[60:63], v[248:251]
    ds_read_b64_tr_b16 v[124:125], v19 offset:40960
    v_mfma_f32_16x16x32_bf16 v[252:255], v[188:191], v[60:63], v[252:255]
    ds_read_b64_tr_b16 v[126:127], v19 offset:43008
    s_waitcnt vmcnt(11) lgkmcnt(14)
    v_mfma_f32_16x16x32_bf16 v[224:227], v[192:195], v[72:75], v[224:227]
    v_add_u32 v8, 0x24000, v8
    v_add_u32 v9, 0x24000, v9
    v_mfma_f32_16x16x32_bf16 v[228:231], v[196:199], v[72:75], v[228:231]
    v_add_u32 v10, 0x24000, v10
    v_mfma_f32_16x16x32_bf16 v[232:235], v[200:203], v[72:75], v[232:235]
    v_add_u32 v19, 0x24000, v19
    ds_read_b64_tr_b16 v[128:129], v8 offset:0
    v_mfma_f32_16x16x32_bf16 v[236:239], v[204:207], v[72:75], v[236:239]
    ds_read_b64_tr_b16 v[130:131], v8 offset:2048
    s_waitcnt vmcnt(10)
    v_mfma_f32_16x16x32_bf16 v[240:243], v[192:195], v[76:79], v[240:243]
    ds_read_b64_tr_b16 v[132:133], v9 offset:0
    ds_read_b64_tr_b16 v[134:135], v9 offset:2048
    v_mfma_f32_16x16x32_bf16 v[244:247], v[196:199], v[76:79], v[244:247]
    ds_read_b64_tr_b16 v[136:137], v10 offset:0
    v_mfma_f32_16x16x32_bf16 v[248:251], v[200:203], v[76:79], v[248:251]
    ds_read_b64_tr_b16 v[138:139], v10 offset:2048
    ds_read_b64_tr_b16 v[140:141], v19 offset:0
    v_mfma_f32_16x16x32_bf16 v[252:255], v[204:207], v[76:79], v[252:255]
    ds_read_b64_tr_b16 v[142:143], v19 offset:2048
    s_waitcnt vmcnt(9)
    v_mfma_f32_16x16x32_bf16 v[224:227], v[208:211], v[88:91], v[224:227]
    ds_read_b64_tr_b16 v[144:145], v8 offset:8192
    v_mfma_f32_16x16x32_bf16 v[228:231], v[212:215], v[88:91], v[228:231]
    ds_read_b64_tr_b16 v[146:147], v8 offset:10240
    v_mfma_f32_16x16x32_bf16 v[232:235], v[216:219], v[88:91], v[232:235]
    ds_read_b64_tr_b16 v[148:149], v9 offset:8192
    v_mfma_f32_16x16x32_bf16 v[236:239], v[220:223], v[88:91], v[236:239]
    ds_read_b64_tr_b16 v[150:151], v9 offset:10240
    s_waitcnt vmcnt(8)
    v_mfma_f32_16x16x32_bf16 v[240:243], v[208:211], v[92:95], v[240:243]
    ds_read_b64_tr_b16 v[152:153], v10 offset:8192
    v_mfma_f32_16x16x32_bf16 v[244:247], v[212:215], v[92:95], v[244:247]
    ds_read_b64_tr_b16 v[154:155], v10 offset:10240
    v_mfma_f32_16x16x32_bf16 v[248:251], v[216:219], v[92:95], v[248:251]
    ds_read_b64_tr_b16 v[156:157], v19 offset:8192
    v_mfma_f32_16x16x32_bf16 v[252:255], v[220:223], v[92:95], v[252:255]
    ds_read_b64_tr_b16 v[158:159], v19 offset:10240
    s_waitcnt vmcnt(7) lgkmcnt(14)
    v_mfma_f32_16x16x32_bf16 v[224:227], v[96:99], v[32:35], v[224:227]
    v_mfma_f32_16x16x32_bf16 v[228:231], v[100:103], v[32:35], v[228:231]
    v_mfma_f32_16x16x32_bf16 v[232:235], v[104:107], v[32:35], v[232:235]
    v_mfma_f32_16x16x32_bf16 v[236:239], v[108:111], v[32:35], v[236:239]
    s_waitcnt vmcnt(6)
    v_mfma_f32_16x16x32_bf16 v[240:243], v[96:99], v[36:39], v[240:243]
    v_mfma_f32_16x16x32_bf16 v[244:247], v[100:103], v[36:39], v[244:247]
    v_mfma_f32_16x16x32_bf16 v[248:251], v[104:107], v[36:39], v[248:251]
    v_mfma_f32_16x16x32_bf16 v[252:255], v[108:111], v[36:39], v[252:255]
    s_waitcnt vmcnt(5)
    v_mfma_f32_16x16x32_bf16 v[224:227], v[112:115], v[48:51], v[224:227]
    v_mfma_f32_16x16x32_bf16 v[228:231], v[116:119], v[48:51], v[228:231]
    v_mfma_f32_16x16x32_bf16 v[232:235], v[120:123], v[48:51], v[232:235]
    v_mfma_f32_16x16x32_bf16 v[236:239], v[124:127], v[48:51], v[236:239]
    s_waitcnt vmcnt(4)
    v_mfma_f32_16x16x32_bf16 v[240:243], v[112:115], v[52:55], v[240:243]
    v_mfma_f32_16x16x32_bf16 v[244:247], v[116:119], v[52:55], v[244:247]
    v_mfma_f32_16x16x32_bf16 v[248:251], v[120:123], v[52:55], v[248:251]
    v_mfma_f32_16x16x32_bf16 v[252:255], v[124:127], v[52:55], v[252:255]
    s_waitcnt vmcnt(3) lgkmcnt(8)
    v_mfma_f32_16x16x32_bf16 v[224:227], v[128:131], v[64:67], v[224:227]
    v_mfma_f32_16x16x32_bf16 v[228:231], v[132:135], v[64:67], v[228:231]
    v_mfma_f32_16x16x32_bf16 v[232:235], v[136:139], v[64:67], v[232:235]
    v_mfma_f32_16x16x32_bf16 v[236:239], v[140:143], v[64:67], v[236:239]
    s_waitcnt vmcnt(2)
    v_mfma_f32_16x16x32_bf16 v[240:243], v[128:131], v[68:71], v[240:243]
    v_mfma_f32_16x16x32_bf16 v[244:247], v[132:135], v[68:71], v[244:247]
    v_mfma_f32_16x16x32_bf16 v[248:251], v[136:139], v[68:71], v[248:251]
    v_mfma_f32_16x16x32_bf16 v[252:255], v[140:143], v[68:71], v[252:255]
    s_waitcnt vmcnt(1) lgkmcnt(0)
    v_mfma_f32_16x16x32_bf16 v[224:227], v[144:147], v[80:83], v[224:227]
    v_xor_b32 v65, 64, v16
    v_mfma_f32_16x16x32_bf16 v[228:231], v[148:151], v[80:83], v[228:231]
    v_mfma_f32_16x16x32_bf16 v[232:235], v[152:155], v[80:83], v[232:235]
    v_xor_b32 v66, 128, v16
    v_mfma_f32_16x16x32_bf16 v[236:239], v[156:159], v[80:83], v[236:239]
    s_waitcnt vmcnt(0)
    v_mfma_f32_16x16x32_bf16 v[240:243], v[144:147], v[84:87], v[240:243]
    v_mfma_f32_16x16x32_bf16 v[244:247], v[148:151], v[84:87], v[244:247]
    v_xor_b32 v67, 192, v16
    v_mfma_f32_16x16x32_bf16 v[248:251], v[152:155], v[84:87], v[248:251]
    v_mfma_f32_16x16x32_bf16 v[252:255], v[156:159], v[84:87], v[252:255]
    s_nop 1
    ds_write_b128 v16, v[224:227] offset:0
    ds_write_b128 v65, v[228:231] offset:0
    ds_write_b128 v66, v[232:235] offset:0
    ds_write_b128 v67, v[236:239] offset:0
    ds_write_b128 v16, v[240:243] offset:4096
    ds_write_b128 v65, v[244:247] offset:4096
    ds_write_b128 v66, v[248:251] offset:4096
    ds_write_b128 v67, v[252:255] offset:4096
    s_waitcnt lgkmcnt(0)
L_final:
    s_barrier
    ds_read_b128 v[64:67], v28
    ds_read_b128 v[72:75], v28 offset:16384
    ds_read_b128 v[68:71], v29
    ds_read_b128 v[76:79], v29 offset:16384
    s_waitcnt lgkmcnt(2)
    v_pk_add_f32 v[64:65], v[64:65], v[72:73]
    v_pk_add_f32 v[66:67], v[66:67], v[74:75]
    v_cvt_pk_bf16_f32 v80, v64, v65
    v_cvt_pk_bf16_f32 v81, v66, v67
    v_lshlrev_b32 v64, 16, v80
    v_and_b32 v65, s55, v80
    v_lshlrev_b32 v66, 16, v81
    v_and_b32 v67, s55, v81
    v_pk_add_f32 v[64:65], v[64:65], v[20:21]
    v_pk_add_f32 v[66:67], v[66:67], v[22:23]
    v_cvt_pk_bf16_f32 v84, v64, v65
    v_cvt_pk_bf16_f32 v85, v66, v67
    s_waitcnt lgkmcnt(0)
    v_pk_add_f32 v[68:69], v[68:69], v[76:77]
    v_pk_add_f32 v[70:71], v[70:71], v[78:79]
    v_cvt_pk_bf16_f32 v82, v68, v69
    v_cvt_pk_bf16_f32 v83, v70, v71
    v_lshlrev_b32 v68, 16, v82
    v_and_b32 v69, s55, v82
    v_lshlrev_b32 v70, 16, v83
    v_and_b32 v71, s55, v83
    v_pk_add_f32 v[68:69], v[68:69], v[24:25]
    v_pk_add_f32 v[70:71], v[70:71], v[26:27]
    v_cvt_pk_bf16_f32 v86, v68, v69
    v_cvt_pk_bf16_f32 v87, v70, v71
    buffer_store_dwordx4 v[84:87], v30, s[24:27], s47 offen sc1
    s_endpgm
L_s_8a:
    buffer_store_dword v18, v17, s[20:23], s50 offen offset:0 sc1
    s_branch L_s_8
L_s_9a:
    buffer_store_dword v18, v17, s[20:23], s50 offen offset:64 sc1
    s_branch L_s_9
L_end:
    s_endpgm
.section .rodata,"a"
.p2align 6
.amdhsa_kernel standalone__mixer_channel_mlp__prompt_kernel
  .amdhsa_next_free_vgpr 256
  .amdhsa_next_free_sgpr 102
  .amdhsa_accum_offset 256
  .amdhsa_group_segment_fixed_size 0
  .amdhsa_kernarg_size 64
  .amdhsa_user_sgpr_count 2
  .amdhsa_user_sgpr_kernarg_segment_ptr 1
  .amdhsa_system_sgpr_workgroup_id_x 1
.end_amdhsa_kernel
```
